```python
import torch

def _softmax(x, axis=-1):
    return torch.softmax(x, dim=axis)
def _gelu(x):
    return torch.nn.functional.gelu(x, approximate="tanh")
def _silu(x):
    return torch.nn.functional.silu(x)
def _sigmoid(x):
    return torch.sigmoid(x)
def _layernorm(x, axis=-1, eps=1e-5):
    m = x.mean(dim=axis, keepdim=True)
    v = x.var(dim=axis, keepdim=True, unbiased=False)
    return (x - m) / torch.sqrt(v + eps)
def _scatter_add(tgt, idx, src, axis=0):
    return tgt.clone().index_add_(axis, idx, src)
def _segment_sum(src, seg, n):
    out = torch.zeros((n,) + src.shape[1:], dtype=src.dtype)
    return out.index_add_(0, seg, src)
def _pad(x, pw):
    flat = tuple(v for pair in reversed(pw) for v in pair)
    return torch.nn.functional.pad(x, flat)

kernel_name = 'gated_mix__linear_kernel_hedgehog__mixer_channel_mlp__prompt'

def setup_inputs():

    _w = (lambda a: (lambda t: t.to(torch.bfloat16) if t.is_floating_point() else t)(torch.as_tensor(a)))
    def _A_setup():
        B, S, D, H = 1, 2048, 512, 32
        Dh = D // H
        return {
            "x": _w((lambda *s: torch.randn(*s, dtype=torch.bfloat16) * 0.05)(B, S, D)),
            "wqkv": _w((lambda *s: torch.randn(*s, dtype=torch.bfloat16) * 0.8)(D, 3 * D)),
            "w_phi": _w((lambda *s: torch.randn(*s, dtype=torch.bfloat16) * 0.8)(H, Dh, Dh) * (Dh ** -0.5)),
            "wo": _w((lambda *s: torch.randn(*s, dtype=torch.bfloat16) * 0.1)(D, D)),
        }
    _A_in = _A_setup()

    def _B_setup():
        B, S, D, F = 1, 2048, 512, 1376
        return {
            "x": _w((lambda *s: torch.randn(*s, dtype=torch.bfloat16) * 0.05)(B, S, D)),
            "w1": _w((lambda *s: torch.randn(*s, dtype=torch.bfloat16) * 0.8)(D, F) * (D ** -0.5)),
            "b1": _w((lambda *s: torch.randn(*s, dtype=torch.bfloat16) * 0.4)(F)),
            "w2": _w((lambda *s: torch.randn(*s, dtype=torch.bfloat16) * 0.05)(F, D) * (F ** -0.5)),
            "b2": _w((lambda *s: torch.randn(*s, dtype=torch.bfloat16) * 0.05)(D)),
        }
    _B_in = _B_setup()

    return {
        "A_x": _A_in["x"],
        "A_wqkv": _A_in["wqkv"],
        "A_w_phi": _A_in["w_phi"],
        "A_wo": _A_in["wo"],
        "B_x": _B_in["x"],
        "B_w1": _B_in["w1"],
        "B_b1": _B_in["b1"],
        "B_w2": _B_in["w2"],
        "B_b2": _B_in["b2"],
        "gate_w": _w((lambda *s: torch.randn(*s, dtype=torch.bfloat16) * 0.05)(512) * 16.0),
    }

def reference(A_x, A_wqkv, A_w_phi, A_wo, B_x, B_w1, B_b1, B_w2, B_b2, gate_w):
    def _A_ref(x, wqkv, w_phi, wo):
        B, S, D = x.shape
        H = 32; Dh = D // H
        qkv = (lambda x, *d: x.permute(*d))((x @ wqkv).reshape(B, S, 3, H, Dh), 2, 0, 3, 1, 4)
        q, k, v = qkv[0], qkv[1], qkv[2]
        pq = torch.einsum("bhsd,hdf->bhsf", q, w_phi)
        pk = torch.einsum("bhsd,hdf->bhsf", k, w_phi)
        phi_q = torch.concatenate([_softmax(pq, axis=-1), _softmax(-pq, axis=-1)], axis=-1)
        phi_k = torch.concatenate([_softmax(pk, axis=-1), _softmax(-pk, axis=-1)], axis=-1)
        kv = torch.einsum("bhsf,bhsd->bhfd", phi_k, v)
        z  = torch.einsum("bhsf->bhf", phi_k)
        num = torch.einsum("bhqf,bhfd->bhqd", phi_q, kv)
        den = torch.einsum("bhqf,bhf->bhq", phi_q, z)[..., None] + 1e-6
        o = num / den
        return (lambda x, *d: x.permute(*d))(o, 0, 2, 1, 3).reshape(B, S, D) @ wo

    def _B_ref(x, w1, b1, w2, b2):
        y = _layernorm(x, axis=-1)
        h = _gelu(torch.einsum("bsd,df->bsf", y, w1) + b1)
        return torch.einsum("bsf,fd->bsd", h, w2) + b2

    x = A_x
    g = _sigmoid((x * gate_w).sum(-1, keepdims=True))
    a = _A_ref(x, A_wqkv, A_w_phi, A_wo)
    b = _B_ref(x, B_w1, B_b1, B_w2, B_b2)
    return g * a + (1 - g) * b
```

```asm
; @launch kernel=fused_kernel grid=(256,1,1) block=(512,1,1) lds=163840
.amdgcn_target "amdgcn-amd-amdhsa--gfx950"
.text
.globl fused_kernel
.p2align 8
.type fused_kernel,@function
fused_kernel:
    s_cmp_ge_u32 s2, 256
    s_cbranch_scc1 k1_exit
    s_load_dwordx16 s[32:47], s[0:1], 0
    s_load_dwordx8 s[48:55], s[0:1], 64
    s_load_dwordx2 s[56:57], s[0:1], 96
    v_and_b32 v1, 63, v0
    v_lshrrev_b32 v2, 6, v0
    s_nop 0
    v_readfirstlane_b32 s6, v2
    s_and_b32 s3, s2, 7
    s_lshr_b32 s59, s2, 3
    s_lshr_b32 s4, s3, 1
    s_lshl_b32 s4, s4, 2
    s_lshr_b32 s5, s59, 3
    s_add_u32 s4, s4, s5
    s_and_b32 s5, s59, 7
    s_and_b32 s68, s3, 1
    s_and_b32 s7, s6, 3
    s_lshr_b32 s58, s6, 2
    s_waitcnt lgkmcnt(0)
    s_cmp_lg_u32 s2, 0
    s_cbranch_scc1 k1_noinit
    s_add_u32 s8, s56, 10485760
    s_addc_u32 s9, s57, 0
    s_mov_b32 s10, 2097152
    s_mov_b32 s11, 0x00020000
    v_lshlrev_b32 v2, 4, v1
    v_mov_b32 v4, 0
    v_mov_b32 v5, 0
    v_mov_b32 v6, 0
    v_mov_b32 v7, 0
    s_lshl_b32 s3, s6, 14
    s_add_u32 s59, s3, 0
    buffer_store_dwordx4 v[4:7], v2, s[8:11], s59 offen sc1
    s_add_u32 s59, s3, 1024
    buffer_store_dwordx4 v[4:7], v2, s[8:11], s59 offen sc1
    s_add_u32 s59, s3, 2048
    buffer_store_dwordx4 v[4:7], v2, s[8:11], s59 offen sc1
    s_add_u32 s59, s3, 3072
    buffer_store_dwordx4 v[4:7], v2, s[8:11], s59 offen sc1
    s_add_u32 s59, s3, 4096
    buffer_store_dwordx4 v[4:7], v2, s[8:11], s59 offen sc1
    s_add_u32 s59, s3, 5120
    buffer_store_dwordx4 v[4:7], v2, s[8:11], s59 offen sc1
    s_add_u32 s59, s3, 6144
    buffer_store_dwordx4 v[4:7], v2, s[8:11], s59 offen sc1
    s_add_u32 s59, s3, 7168
    buffer_store_dwordx4 v[4:7], v2, s[8:11], s59 offen sc1
    s_add_u32 s59, s3, 8192
    buffer_store_dwordx4 v[4:7], v2, s[8:11], s59 offen sc1
    s_add_u32 s59, s3, 9216
    buffer_store_dwordx4 v[4:7], v2, s[8:11], s59 offen sc1
    s_add_u32 s59, s3, 10240
    buffer_store_dwordx4 v[4:7], v2, s[8:11], s59 offen sc1
    s_add_u32 s59, s3, 11264
    buffer_store_dwordx4 v[4:7], v2, s[8:11], s59 offen sc1
    s_add_u32 s59, s3, 12288
    buffer_store_dwordx4 v[4:7], v2, s[8:11], s59 offen sc1
    s_add_u32 s59, s3, 13312
    buffer_store_dwordx4 v[4:7], v2, s[8:11], s59 offen sc1
    s_add_u32 s59, s3, 14336
    buffer_store_dwordx4 v[4:7], v2, s[8:11], s59 offen sc1
    s_add_u32 s59, s3, 15360
    buffer_store_dwordx4 v[4:7], v2, s[8:11], s59 offen sc1
    s_cmp_lg_u32 s6, 7
    s_cbranch_scc1 k1_noinit
    s_add_u32 s8, s56, 12713984
    s_addc_u32 s9, s57, 0
    s_mov_b32 s10, 8192
    s_mov_b32 s11, 0x00020000
    v_and_b32 v2, 31, v1
    v_mul_u32_u24 v2, 256, v2
    v_lshrrev_b32 v3, 5, v1
    v_lshl_add_u32 v2, v3, 4, v2
    buffer_store_dwordx4 v[4:7], v2, s[8:11], 0 offen sc1
k1_noinit:
    s_nop 7
    s_nop 7
    v_mov_b32 v2, 155648
    v_lshl_add_u32 v2, v1, 2, v2
    v_mov_b32 v3, 0
    v_cmp_gt_u32 vcc, 16, v1
    s_nop 0
    s_and_saveexec_b64 s[60:61], vcc
    ds_write_b32 v2, v3
    s_mov_b64 exec, s[60:61]
    s_cmp_eq_u32 s68, 0
    s_cbranch_scc0 k1_mlp
    s_mov_b32 s8, s32
    s_mov_b32 s9, s33
    s_mov_b32 s10, 2097152
    s_mov_b32 s11, 0x00020000
    s_mov_b32 s12, s34
    s_mov_b32 s13, s35
    s_mov_b32 s14, 1572864
    s_mov_b32 s15, 0x00020000
    s_mov_b32 s16, s36
    s_mov_b32 s17, s37
    s_mov_b32 s18, 16384
    s_mov_b32 s19, 0x00020000
    s_add_u32 s24, s56, 6291456
    s_addc_u32 s25, s57, 0
    s_mov_b32 s26, 4194304
    s_mov_b32 s27, 0x00020000
    s_add_u32 s28, s56, 10485760
    s_addc_u32 s29, s57, 0
    s_mov_b32 s30, 2097152
    s_mov_b32 s31, 0x00020000
    v_and_b32 v7, 31, v1
    v_lshrrev_b32 v15, 5, v1
    s_lshl_b32 s3, s5, 2
    s_lshl_b32 s59, s58, 1
    s_add_u32 s3, s3, s59
    v_lshrrev_b32 v132, 4, v7
    v_add_u32 v132, s3, v132
    v_lshlrev_b32 v132, 9, v132
    v_and_b32 v133, 15, v7
    v_lshl_add_u32 v132, v133, 1, v132
    v_lshl_add_u32 v132, v15, 7, v132
    v_xor_b32 v133, 2048, v132
    buffer_load_ushort v148, v133, s[16:19], 0 offen offset:0
    buffer_load_ushort v149, v133, s[16:19], 0 offen offset:32
    buffer_load_ushort v150, v133, s[16:19], 0 offen offset:64
    buffer_load_ushort v151, v133, s[16:19], 0 offen offset:96
    buffer_load_ushort v152, v133, s[16:19], 0 offen offset:256
    buffer_load_ushort v153, v133, s[16:19], 0 offen offset:288
    buffer_load_ushort v154, v133, s[16:19], 0 offen offset:320
    buffer_load_ushort v155, v133, s[16:19], 0 offen offset:352
    buffer_load_ushort v140, v132, s[16:19], 0 offen offset:0
    buffer_load_ushort v141, v132, s[16:19], 0 offen offset:32
    buffer_load_ushort v142, v132, s[16:19], 0 offen offset:64
    buffer_load_ushort v143, v132, s[16:19], 0 offen offset:96
    buffer_load_ushort v144, v132, s[16:19], 0 offen offset:256
    buffer_load_ushort v145, v132, s[16:19], 0 offen offset:288
    buffer_load_ushort v146, v132, s[16:19], 0 offen offset:320
    buffer_load_ushort v147, v132, s[16:19], 0 offen offset:352
    v_lshrrev_b32 v132, 3, v1
    s_lshl_b32 s3, s4, 7
    s_lshl_b32 s59, s6, 4
    s_add_u32 s3, s3, s59
    v_add_u32 v132, s3, v132
    v_lshlrev_b32 v132, 10, v132
    v_and_b32 v133, 7, v1
    v_lshrrev_b32 v134, 4, v1
    v_xor_b32 v135, v133, v134
    v_lshl_add_u32 v2, v135, 4, v132
    v_xor_b32 v135, 4, v135
    v_lshl_add_u32 v3, v135, 4, v132
    v_add_u32 v3, 8192, v3
    v_bfe_u32 v132, v1, 2, 2
    s_lshl_b32 s3, s6, 3
    v_add_u32 v132, s3, v132
    s_mov_b32 s59, 3072
    v_mul_lo_u32 v132, v132, s59
    v_and_b32 v133, 3, v1
    v_lshl_add_u32 v132, v133, 4, v132
    s_mul_i32 s3, s5, 128
    v_add_u32 v132, s3, v132
    v_lshrrev_b32 v134, 4, v1
    s_and_b32 s3, s5, 1
    s_lshl_b32 s3, s3, 8
    s_sub_u32 s3, 128, s3
    v_mov_b32 v139, s3
    v_lshrrev_b32 v136, 1, v134
    v_mul_u32_u24 v136, 1024, v136
    v_and_b32 v137, 1, v134
    v_lshl_add_u32 v136, v137, 6, v136
    v_add_u32 v4, v132, v136
    v_cmp_gt_u32 s[70:71], 2, v134
    s_nop 1
    v_cndmask_b32 v137, 0, v139, s[70:71]
    v_add_u32 v4, v4, v137
    v_add_u32 v135, 4, v134
    v_subrev_u32 v138, 2, v134
    v_cmp_gt_u32 vcc, 32, v1
    s_nop 1
    v_cndmask_b32 v135, v138, v135, vcc
    v_lshrrev_b32 v136, 1, v135
    v_mul_u32_u24 v136, 1024, v136
    v_and_b32 v137, 1, v135
    v_lshl_add_u32 v136, v137, 6, v136
    v_add_u32 v5, v132, v136
    v_cmp_gt_u32 s[70:71], 2, v135
    s_nop 1
    v_cndmask_b32 v137, 0, v139, s[70:71]
    v_add_u32 v5, v5, v137
    v_mov_b32 v138, 12288
    v_cndmask_b32 v138, v138, 0, vcc
    v_add_u32 v5, v5, v138
    v_add_u32 v135, 2, v134
    v_lshrrev_b32 v136, 1, v135
    v_mul_u32_u24 v136, 1024, v136
    v_and_b32 v137, 1, v135
    v_lshl_add_u32 v136, v137, 6, v136
    v_add_u32 v6, v132, v136
    v_cmp_gt_u32 s[70:71], 2, v135
    s_nop 1
    v_cndmask_b32 v137, 0, v139, s[70:71]
    v_add_u32 v6, v6, v137
    v_add_u32 v6, 12288, v6
    s_lshl_b32 s60, s6, 11
    s_add_u32 s60, s60, 73728
    s_mul_i32 s61, s6, 3072
    s_mul_i32 s62, s5, 1
    s_add_u32 s62, s62, 0
    s_and_b32 s62, s62, 7
    s_mul_i32 s63, s62, 196608
    s_lshl_b32 s62, s62, 7
    s_add_u32 m0, s60, 0
    s_nop 0
    buffer_load_dwordx4 v2, s[8:11], s62 offen lds
    s_add_u32 m0, s60, 1024
    s_nop 0
    buffer_load_dwordx4 v3, s[8:11], s62 offen lds
    s_add_u32 m0, s61, 0
    s_nop 0
    buffer_load_dwordx4 v4, s[12:15], s63 offen lds
    s_add_u32 m0, s61, 1024
    s_nop 0
    buffer_load_dwordx4 v5, s[12:15], s63 offen lds
    s_add_u32 m0, s61, 2048
    s_nop 0
    buffer_load_dwordx4 v6, s[12:15], s63 offen lds
    s_mul_i32 s62, s5, 1
    s_add_u32 s62, s62, 1
    s_and_b32 s62, s62, 7
    s_mul_i32 s63, s62, 196608
    s_lshl_b32 s62, s62, 7
    s_add_u32 m0, s60, 16384
    s_nop 0
    buffer_load_dwordx4 v2, s[8:11], s62 offen lds
    s_add_u32 m0, s60, 17408
    s_nop 0
    buffer_load_dwordx4 v3, s[8:11], s62 offen lds
    s_add_u32 m0, s61, 24576
    s_nop 0
    buffer_load_dwordx4 v4, s[12:15], s63 offen lds
    s_add_u32 m0, s61, 25600
    s_nop 0
    buffer_load_dwordx4 v5, s[12:15], s63 offen lds
    s_add_u32 m0, s61, 26624
    s_nop 0
    buffer_load_dwordx4 v6, s[12:15], s63 offen lds
    s_lshl_b32 s3, s7, 5
    v_add_u32 v132, s3, v7
    v_lshlrev_b32 v132, 7, v132
    v_add_u32 v132, 73728, v132
    v_bfe_u32 v133, v7, 1, 3
    v_xor_b32 v133, v133, v15
    v_xor_b32 v134, 0, v133
    v_lshl_add_u32 v8, v134, 4, v132
    v_xor_b32 v134, 2, v133
    v_lshl_add_u32 v9, v134, 4, v132
    v_xor_b32 v134, 4, v133
    v_lshl_add_u32 v10, v134, 4, v132
    v_xor_b32 v134, 6, v133
    v_lshl_add_u32 v11, v134, 4, v132
    v_mul_u32_u24 v12, 3072, v15
    v_bfe_u32 v132, v1, 2, 2
    v_lshl_add_u32 v12, v132, 6, v12
    v_bfe_u32 v132, v1, 4, 1
    v_lshl_add_u32 v12, v132, 5, v12
    v_and_b32 v132, 3, v1
    v_lshl_add_u32 v12, v132, 3, v12
    s_lshl_b32 s3, s58, 8
    v_add_u32 v12, s3, v12
    v_add_u32 v13, 49152, v12
    v_lshlrev_b32 v132, 2, v15
    v_sub_u32 v132, v7, v132
    v_cmp_eq_u32 vcc, 0, v132
    v_mov_b32 v133, 0x3f80
    s_nop 0
    v_cndmask_b32 v124, 0, v133, vcc
    v_cmp_eq_u32 vcc, 1, v132
    v_mov_b32 v133, 0x3f800000
    s_nop 0
    v_cndmask_b32 v133, 0, v133, vcc
    v_or_b32 v124, v124, v133
    v_cmp_eq_u32 vcc, 2, v132
    v_mov_b32 v133, 0x3f80
    s_nop 0
    v_cndmask_b32 v125, 0, v133, vcc
    v_cmp_eq_u32 vcc, 3, v132
    v_mov_b32 v133, 0x3f800000
    s_nop 0
    v_cndmask_b32 v133, 0, v133, vcc
    v_or_b32 v125, v125, v133
    v_cmp_eq_u32 vcc, 8, v132
    v_mov_b32 v133, 0x3f80
    s_nop 0
    v_cndmask_b32 v126, 0, v133, vcc
    v_cmp_eq_u32 vcc, 9, v132
    v_mov_b32 v133, 0x3f800000
    s_nop 0
    v_cndmask_b32 v133, 0, v133, vcc
    v_or_b32 v126, v126, v133
    v_cmp_eq_u32 vcc, 10, v132
    v_mov_b32 v133, 0x3f80
    s_nop 0
    v_cndmask_b32 v127, 0, v133, vcc
    v_cmp_eq_u32 vcc, 11, v132
    v_mov_b32 v133, 0x3f800000
    s_nop 0
    v_cndmask_b32 v133, 0, v133, vcc
    v_or_b32 v127, v127, v133
    v_cmp_eq_u32 vcc, 16, v132
    v_mov_b32 v133, 0x3f80
    s_nop 0
    v_cndmask_b32 v128, 0, v133, vcc
    v_cmp_eq_u32 vcc, 17, v132
    v_mov_b32 v133, 0x3f800000
    s_nop 0
    v_cndmask_b32 v133, 0, v133, vcc
    v_or_b32 v128, v128, v133
    v_cmp_eq_u32 vcc, 18, v132
    v_mov_b32 v133, 0x3f80
    s_nop 0
    v_cndmask_b32 v129, 0, v133, vcc
    v_cmp_eq_u32 vcc, 19, v132
    v_mov_b32 v133, 0x3f800000
    s_nop 0
    v_cndmask_b32 v133, 0, v133, vcc
    v_or_b32 v129, v129, v133
    v_cmp_eq_u32 vcc, 24, v132
    v_mov_b32 v133, 0x3f80
    s_nop 0
    v_cndmask_b32 v130, 0, v133, vcc
    v_cmp_eq_u32 vcc, 25, v132
    v_mov_b32 v133, 0x3f800000
    s_nop 0
    v_cndmask_b32 v133, 0, v133, vcc
    v_or_b32 v130, v130, v133
    v_cmp_eq_u32 vcc, 26, v132
    v_mov_b32 v133, 0x3f80
    s_nop 0
    v_cndmask_b32 v131, 0, v133, vcc
    v_cmp_eq_u32 vcc, 27, v132
    v_mov_b32 v133, 0x3f800000
    s_nop 0
    v_cndmask_b32 v133, 0, v133, vcc
    v_or_b32 v131, v131, v133
    s_mov_b32 s64, 1065369472
    s_mov_b32 s68, s46
    s_mov_b32 s69, s47
    s_mov_b32 s70, 1409024
    s_mov_b32 s71, 0x00020000
    s_mov_b32 s76, s38
    s_mov_b32 s77, s39
    s_mov_b32 s78, 524288
    s_mov_b32 s79, 0x00020000
    s_lshr_b32 s67, s2, 3
    s_lshl_b32 s67, s67, 3
    s_add_u32 s67, s67, s6
    s_lshl_b32 s67, s67, 10
    v_lshlrev_b32 v111, 4, v1
    s_lshl_b32 s66, s6, 10
    s_add_u32 s66, s66, 131072
    s_mov_b32 s72, s54
    s_mov_b32 s73, s55
    s_mov_b32 s74, 256
    s_mov_b32 s75, 0x00020000
    v_mov_b32 v251, 0
    v_mov_b32 v249, 0
    s_waitcnt vmcnt(5)
    s_barrier
    s_cmp_lg_u32 s2, 0
    s_cbranch_scc1 k1_noinit2
    s_cmp_lg_u32 s6, 7
    s_cbranch_scc1 k1_noinit2
    s_mov_b32 s72, s54
    s_mov_b32 s73, s55
    s_mov_b32 s74, 256
    s_mov_b32 s75, 0x00020000
    v_mov_b32 v132, 1
    v_mov_b32 v133, 0
    buffer_store_dword v132, v133, s[72:75], 0 offen sc1
k1_noinit2:
    s_nop 7
    s_nop 7
    ds_read_b128 v[64:67], v8 offset:0
    ds_read_b64_tr_b16 v[68:69], v12 offset:0
    ds_read_b64_tr_b16 v[70:71], v12 offset:1536
    ds_read_b64_tr_b16 v[72:73], v12 offset:512
    ds_read_b64_tr_b16 v[74:75], v12 offset:2048
    ds_read_b64_tr_b16 v[76:77], v12 offset:1024
    ds_read_b64_tr_b16 v[78:79], v12 offset:2560
    s_mul_i32 s62, s5, 1
    s_add_u32 s62, s62, 2
    s_and_b32 s62, s62, 7
    s_mul_i32 s63, s62, 196608
    s_lshl_b32 s62, s62, 7
    ds_read_b128 v[80:83], v9 offset:0
    ds_read_b64_tr_b16 v[84:85], v12 offset:6144
    ds_read_b64_tr_b16 v[86:87], v12 offset:7680
    ds_read_b64_tr_b16 v[88:89], v12 offset:6656
    ds_read_b64_tr_b16 v[90:91], v12 offset:8192
    ds_read_b64_tr_b16 v[92:93], v12 offset:7168
    ds_read_b64_tr_b16 v[94:95], v12 offset:8704
    s_waitcnt lgkmcnt(7)
    v_mfma_f32_32x32x16_bf16 v[16:31], v[68:71], v[64:67], 0
    s_add_u32 m0, s60, 32768
    s_nop 0
    buffer_load_dwordx4 v2, s[8:11], s62 offen lds
    v_mfma_f32_32x32x16_bf16 v[32:47], v[72:75], v[64:67], 0
    v_mfma_f32_32x32x16_bf16 v[48:63], v[64:67], v[76:79], 0
    ds_read_b128 v[64:67], v10 offset:0
    ds_read_b64_tr_b16 v[68:69], v12 offset:12288
    ds_read_b64_tr_b16 v[70:71], v12 offset:13824
    ds_read_b64_tr_b16 v[72:73], v12 offset:12800
    ds_read_b64_tr_b16 v[74:75], v12 offset:14336
    ds_read_b64_tr_b16 v[76:77], v12 offset:13312
    ds_read_b64_tr_b16 v[78:79], v12 offset:14848
    s_waitcnt lgkmcnt(7)
    v_mfma_f32_32x32x16_bf16 v[16:31], v[84:87], v[80:83], v[16:31]
    s_add_u32 m0, s60, 33792
    s_nop 0
    buffer_load_dwordx4 v3, s[8:11], s62 offen lds
    v_mfma_f32_32x32x16_bf16 v[32:47], v[88:91], v[80:83], v[32:47]
    v_mfma_f32_32x32x16_bf16 v[48:63], v[80:83], v[92:95], v[48:63]
    ds_read_b128 v[80:83], v11 offset:0
    ds_read_b64_tr_b16 v[84:85], v12 offset:18432
    ds_read_b64_tr_b16 v[86:87], v12 offset:19968
    ds_read_b64_tr_b16 v[88:89], v12 offset:18944
    ds_read_b64_tr_b16 v[90:91], v12 offset:20480
    ds_read_b64_tr_b16 v[92:93], v12 offset:19456
    ds_read_b64_tr_b16 v[94:95], v12 offset:20992
    s_waitcnt lgkmcnt(7)
    v_mfma_f32_32x32x16_bf16 v[16:31], v[68:71], v[64:67], v[16:31]
    s_add_u32 m0, s61, 49152
    s_nop 0
    buffer_load_dwordx4 v4, s[12:15], s63 offen lds
    v_mfma_f32_32x32x16_bf16 v[32:47], v[72:75], v[64:67], v[32:47]
    v_mfma_f32_32x32x16_bf16 v[48:63], v[64:67], v[76:79], v[48:63]
    s_waitcnt lgkmcnt(0)
    v_mfma_f32_32x32x16_bf16 v[16:31], v[84:87], v[80:83], v[16:31]
    s_add_u32 m0, s61, 50176
    s_nop 0
    buffer_load_dwordx4 v5, s[12:15], s63 offen lds
    v_mfma_f32_32x32x16_bf16 v[32:47], v[88:91], v[80:83], v[32:47]
    v_mfma_f32_32x32x16_bf16 v[48:63], v[80:83], v[92:95], v[48:63]
    s_add_u32 m0, s61, 51200
    s_nop 0
    buffer_load_dwordx4 v6, s[12:15], s63 offen lds
    s_add_u32 s3, s67, 0
    s_mov_b32 m0, s66
    s_nop 0
    buffer_load_dwordx4 v111, s[68:71], s3 offen lds
    s_add_u32 s3, s67, 262144
    s_mov_b32 m0, s66
    s_nop 0
    buffer_load_dwordx4 v111, s[68:71], s3 offen lds
    s_waitcnt vmcnt(7)
    s_barrier
    ds_read_b128 v[64:67], v8 offset:16384
    ds_read_b64_tr_b16 v[68:69], v12 offset:24576
    ds_read_b64_tr_b16 v[70:71], v12 offset:26112
    ds_read_b64_tr_b16 v[72:73], v12 offset:25088
    ds_read_b64_tr_b16 v[74:75], v12 offset:26624
    ds_read_b64_tr_b16 v[76:77], v12 offset:25600
    ds_read_b64_tr_b16 v[78:79], v12 offset:27136
    s_mul_i32 s62, s5, 1
    s_add_u32 s62, s62, 3
    s_and_b32 s62, s62, 7
    s_mul_i32 s63, s62, 196608
    s_lshl_b32 s62, s62, 7
    ds_read_b128 v[80:83], v9 offset:16384
    ds_read_b64_tr_b16 v[84:85], v12 offset:30720
    ds_read_b64_tr_b16 v[86:87], v12 offset:32256
    ds_read_b64_tr_b16 v[88:89], v12 offset:31232
    ds_read_b64_tr_b16 v[90:91], v12 offset:32768
    ds_read_b64_tr_b16 v[92:93], v12 offset:31744
    ds_read_b64_tr_b16 v[94:95], v12 offset:33280
    s_waitcnt lgkmcnt(7)
    v_mfma_f32_32x32x16_bf16 v[16:31], v[68:71], v[64:67], v[16:31]
    s_add_u32 m0, s60, 0
    s_nop 0
    buffer_load_dwordx4 v2, s[8:11], s62 offen lds
    v_mfma_f32_32x32x16_bf16 v[32:47], v[72:75], v[64:67], v[32:47]
    v_mfma_f32_32x32x16_bf16 v[48:63], v[64:67], v[76:79], v[48:63]
    ds_read_b128 v[64:67], v10 offset:16384
    ds_read_b64_tr_b16 v[68:69], v12 offset:36864
    ds_read_b64_tr_b16 v[70:71], v12 offset:38400
    ds_read_b64_tr_b16 v[72:73], v12 offset:37376
    ds_read_b64_tr_b16 v[74:75], v12 offset:38912
    ds_read_b64_tr_b16 v[76:77], v12 offset:37888
    ds_read_b64_tr_b16 v[78:79], v12 offset:39424
    s_waitcnt lgkmcnt(7)
    v_mfma_f32_32x32x16_bf16 v[16:31], v[84:87], v[80:83], v[16:31]
    s_add_u32 m0, s60, 1024
    s_nop 0
    buffer_load_dwordx4 v3, s[8:11], s62 offen lds
    v_mfma_f32_32x32x16_bf16 v[32:47], v[88:91], v[80:83], v[32:47]
    v_mfma_f32_32x32x16_bf16 v[48:63], v[80:83], v[92:95], v[48:63]
    ds_read_b128 v[80:83], v11 offset:16384
    ds_read_b64_tr_b16 v[84:85], v12 offset:43008
    ds_read_b64_tr_b16 v[86:87], v12 offset:44544
    ds_read_b64_tr_b16 v[88:89], v12 offset:43520
    ds_read_b64_tr_b16 v[90:91], v12 offset:45056
    ds_read_b64_tr_b16 v[92:93], v12 offset:44032
    ds_read_b64_tr_b16 v[94:95], v12 offset:45568
    s_waitcnt lgkmcnt(7)
    v_mfma_f32_32x32x16_bf16 v[16:31], v[68:71], v[64:67], v[16:31]
    s_add_u32 m0, s61, 0
    s_nop 0
    buffer_load_dwordx4 v4, s[12:15], s63 offen lds
    v_mfma_f32_32x32x16_bf16 v[32:47], v[72:75], v[64:67], v[32:47]
    v_mfma_f32_32x32x16_bf16 v[48:63], v[64:67], v[76:79], v[48:63]
    s_waitcnt lgkmcnt(0)
    v_mfma_f32_32x32x16_bf16 v[16:31], v[84:87], v[80:83], v[16:31]
    s_add_u32 m0, s61, 1024
    s_nop 0
    buffer_load_dwordx4 v5, s[12:15], s63 offen lds
    v_mfma_f32_32x32x16_bf16 v[32:47], v[88:91], v[80:83], v[32:47]
    v_mfma_f32_32x32x16_bf16 v[48:63], v[80:83], v[92:95], v[48:63]
    s_add_u32 m0, s61, 2048
    s_nop 0
    buffer_load_dwordx4 v6, s[12:15], s63 offen lds
    s_add_u32 s3, s67, 524288
    s_mov_b32 m0, s66
    s_nop 0
    buffer_load_dwordx4 v111, s[68:71], s3 offen lds
    s_add_u32 s3, s67, 786432
    s_mov_b32 m0, s66
    s_nop 0
    buffer_load_dwordx4 v111, s[68:71], s3 offen lds
    s_waitcnt vmcnt(7)
    s_barrier
    ds_read_b128 v[64:67], v8 offset:32768
    ds_read_b64_tr_b16 v[68:69], v13 offset:0
    ds_read_b64_tr_b16 v[70:71], v13 offset:1536
    ds_read_b64_tr_b16 v[72:73], v13 offset:512
    ds_read_b64_tr_b16 v[74:75], v13 offset:2048
    ds_read_b64_tr_b16 v[76:77], v13 offset:1024
    ds_read_b64_tr_b16 v[78:79], v13 offset:2560
    s_mul_i32 s62, s5, 1
    s_add_u32 s62, s62, 4
    s_and_b32 s62, s62, 7
    s_mul_i32 s63, s62, 196608
    s_lshl_b32 s62, s62, 7
    ds_read_b128 v[80:83], v9 offset:32768
    ds_read_b64_tr_b16 v[84:85], v13 offset:6144
    ds_read_b64_tr_b16 v[86:87], v13 offset:7680
    ds_read_b64_tr_b16 v[88:89], v13 offset:6656
    ds_read_b64_tr_b16 v[90:91], v13 offset:8192
    ds_read_b64_tr_b16 v[92:93], v13 offset:7168
    ds_read_b64_tr_b16 v[94:95], v13 offset:8704
    s_waitcnt lgkmcnt(7)
    v_mfma_f32_32x32x16_bf16 v[16:31], v[68:71], v[64:67], v[16:31]
    s_add_u32 m0, s60, 16384
    s_nop 0
    buffer_load_dwordx4 v2, s[8:11], s62 offen lds
    v_mfma_f32_32x32x16_bf16 v[32:47], v[72:75], v[64:67], v[32:47]
    v_mfma_f32_32x32x16_bf16 v[48:63], v[64:67], v[76:79], v[48:63]
    ds_read_b128 v[64:67], v10 offset:32768
    ds_read_b64_tr_b16 v[68:69], v13 offset:12288
    ds_read_b64_tr_b16 v[70:71], v13 offset:13824
    ds_read_b64_tr_b16 v[72:73], v13 offset:12800
    ds_read_b64_tr_b16 v[74:75], v13 offset:14336
    ds_read_b64_tr_b16 v[76:77], v13 offset:13312
    ds_read_b64_tr_b16 v[78:79], v13 offset:14848
    s_waitcnt lgkmcnt(7)
    v_mfma_f32_32x32x16_bf16 v[16:31], v[84:87], v[80:83], v[16:31]
    s_add_u32 m0, s60, 17408
    s_nop 0
    buffer_load_dwordx4 v3, s[8:11], s62 offen lds
    v_mfma_f32_32x32x16_bf16 v[32:47], v[88:91], v[80:83], v[32:47]
    v_mfma_f32_32x32x16_bf16 v[48:63], v[80:83], v[92:95], v[48:63]
    ds_read_b128 v[80:83], v11 offset:32768
    ds_read_b64_tr_b16 v[84:85], v13 offset:18432
    ds_read_b64_tr_b16 v[86:87], v13 offset:19968
    ds_read_b64_tr_b16 v[88:89], v13 offset:18944
    ds_read_b64_tr_b16 v[90:91], v13 offset:20480
    ds_read_b64_tr_b16 v[92:93], v13 offset:19456
    ds_read_b64_tr_b16 v[94:95], v13 offset:20992
    s_waitcnt lgkmcnt(7)
    v_mfma_f32_32x32x16_bf16 v[16:31], v[68:71], v[64:67], v[16:31]
    s_add_u32 m0, s61, 24576
    s_nop 0
    buffer_load_dwordx4 v4, s[12:15], s63 offen lds
    v_mfma_f32_32x32x16_bf16 v[32:47], v[72:75], v[64:67], v[32:47]
    v_mfma_f32_32x32x16_bf16 v[48:63], v[64:67], v[76:79], v[48:63]
    s_waitcnt lgkmcnt(0)
    v_mfma_f32_32x32x16_bf16 v[16:31], v[84:87], v[80:83], v[16:31]
    s_add_u32 m0, s61, 25600
    s_nop 0
    buffer_load_dwordx4 v5, s[12:15], s63 offen lds
    v_mfma_f32_32x32x16_bf16 v[32:47], v[88:91], v[80:83], v[32:47]
    v_mfma_f32_32x32x16_bf16 v[48:63], v[80:83], v[92:95], v[48:63]
    s_add_u32 m0, s61, 26624
    s_nop 0
    buffer_load_dwordx4 v6, s[12:15], s63 offen lds
    s_add_u32 s3, s67, 1048576
    s_mov_b32 m0, s66
    s_nop 0
    buffer_load_dwordx4 v111, s[68:71], s3 offen lds
    s_add_u32 s3, s67, 1310720
    s_mov_b32 m0, s66
    s_nop 0
    buffer_load_dwordx4 v111, s[68:71], s3 offen lds
    s_waitcnt vmcnt(7)
    s_barrier
    ds_read_b128 v[64:67], v8 offset:0
    ds_read_b64_tr_b16 v[68:69], v12 offset:0
    ds_read_b64_tr_b16 v[70:71], v12 offset:1536
    ds_read_b64_tr_b16 v[72:73], v12 offset:512
    ds_read_b64_tr_b16 v[74:75], v12 offset:2048
    ds_read_b64_tr_b16 v[76:77], v12 offset:1024
    ds_read_b64_tr_b16 v[78:79], v12 offset:2560
    s_mul_i32 s62, s5, 1
    s_add_u32 s62, s62, 5
    s_and_b32 s62, s62, 7
    s_mul_i32 s63, s62, 196608
    s_lshl_b32 s62, s62, 7
    ds_read_b128 v[80:83], v9 offset:0
    ds_read_b64_tr_b16 v[84:85], v12 offset:6144
    ds_read_b64_tr_b16 v[86:87], v12 offset:7680
    ds_read_b64_tr_b16 v[88:89], v12 offset:6656
    ds_read_b64_tr_b16 v[90:91], v12 offset:8192
    ds_read_b64_tr_b16 v[92:93], v12 offset:7168
    ds_read_b64_tr_b16 v[94:95], v12 offset:8704
    s_waitcnt lgkmcnt(7)
    v_mfma_f32_32x32x16_bf16 v[16:31], v[68:71], v[64:67], v[16:31]
    s_add_u32 m0, s60, 32768
    s_nop 0
    buffer_load_dwordx4 v2, s[8:11], s62 offen lds
    v_mfma_f32_32x32x16_bf16 v[32:47], v[72:75], v[64:67], v[32:47]
    v_mfma_f32_32x32x16_bf16 v[48:63], v[64:67], v[76:79], v[48:63]
    ds_read_b128 v[64:67], v10 offset:0
    ds_read_b64_tr_b16 v[68:69], v12 offset:12288
    ds_read_b64_tr_b16 v[70:71], v12 offset:13824
    ds_read_b64_tr_b16 v[72:73], v12 offset:12800
    ds_read_b64_tr_b16 v[74:75], v12 offset:14336
    ds_read_b64_tr_b16 v[76:77], v12 offset:13312
    ds_read_b64_tr_b16 v[78:79], v12 offset:14848
    s_waitcnt lgkmcnt(7)
    v_mfma_f32_32x32x16_bf16 v[16:31], v[84:87], v[80:83], v[16:31]
    s_add_u32 m0, s60, 33792
    s_nop 0
    buffer_load_dwordx4 v3, s[8:11], s62 offen lds
    v_mfma_f32_32x32x16_bf16 v[32:47], v[88:91], v[80:83], v[32:47]
    v_mfma_f32_32x32x16_bf16 v[48:63], v[80:83], v[92:95], v[48:63]
    ds_read_b128 v[80:83], v11 offset:0
    ds_read_b64_tr_b16 v[84:85], v12 offset:18432
    ds_read_b64_tr_b16 v[86:87], v12 offset:19968
    ds_read_b64_tr_b16 v[88:89], v12 offset:18944
    ds_read_b64_tr_b16 v[90:91], v12 offset:20480
    ds_read_b64_tr_b16 v[92:93], v12 offset:19456
    ds_read_b64_tr_b16 v[94:95], v12 offset:20992
    s_waitcnt lgkmcnt(7)
    v_mfma_f32_32x32x16_bf16 v[16:31], v[68:71], v[64:67], v[16:31]
    s_add_u32 m0, s61, 49152
    s_nop 0
    buffer_load_dwordx4 v4, s[12:15], s63 offen lds
    v_mfma_f32_32x32x16_bf16 v[32:47], v[72:75], v[64:67], v[32:47]
    v_mfma_f32_32x32x16_bf16 v[48:63], v[64:67], v[76:79], v[48:63]
    s_waitcnt lgkmcnt(0)
    v_mfma_f32_32x32x16_bf16 v[16:31], v[84:87], v[80:83], v[16:31]
    s_add_u32 m0, s61, 50176
    s_nop 0
    buffer_load_dwordx4 v5, s[12:15], s63 offen lds
    v_mfma_f32_32x32x16_bf16 v[32:47], v[88:91], v[80:83], v[32:47]
    v_mfma_f32_32x32x16_bf16 v[48:63], v[80:83], v[92:95], v[48:63]
    s_add_u32 m0, s61, 51200
    s_nop 0
    buffer_load_dwordx4 v6, s[12:15], s63 offen lds
    s_add_u32 s3, s67, 0
    s_mov_b32 m0, s66
    s_nop 0
    buffer_load_dwordx4 v111, s[76:79], s3 offen lds
    s_add_u32 s3, s67, 262144
    s_mov_b32 m0, s66
    s_nop 0
    buffer_load_dwordx4 v111, s[76:79], s3 offen lds
    s_waitcnt vmcnt(7)
    s_barrier
    ds_read_b128 v[64:67], v8 offset:16384
    ds_read_b64_tr_b16 v[68:69], v12 offset:24576
    ds_read_b64_tr_b16 v[70:71], v12 offset:26112
    ds_read_b64_tr_b16 v[72:73], v12 offset:25088
    ds_read_b64_tr_b16 v[74:75], v12 offset:26624
    ds_read_b64_tr_b16 v[76:77], v12 offset:25600
    ds_read_b64_tr_b16 v[78:79], v12 offset:27136
    s_mul_i32 s62, s5, 1
    s_add_u32 s62, s62, 6
    s_and_b32 s62, s62, 7
    s_mul_i32 s63, s62, 196608
    s_lshl_b32 s62, s62, 7
    ds_read_b128 v[80:83], v9 offset:16384
    ds_read_b64_tr_b16 v[84:85], v12 offset:30720
    ds_read_b64_tr_b16 v[86:87], v12 offset:32256
    ds_read_b64_tr_b16 v[88:89], v12 offset:31232
    ds_read_b64_tr_b16 v[90:91], v12 offset:32768
    ds_read_b64_tr_b16 v[92:93], v12 offset:31744
    ds_read_b64_tr_b16 v[94:95], v12 offset:33280
    s_waitcnt lgkmcnt(7)
    v_mfma_f32_32x32x16_bf16 v[16:31], v[68:71], v[64:67], v[16:31]
    s_add_u32 m0, s60, 0
    s_nop 0
    buffer_load_dwordx4 v2, s[8:11], s62 offen lds
    v_mfma_f32_32x32x16_bf16 v[32:47], v[72:75], v[64:67], v[32:47]
    v_mfma_f32_32x32x16_bf16 v[48:63], v[64:67], v[76:79], v[48:63]
    ds_read_b128 v[64:67], v10 offset:16384
    ds_read_b64_tr_b16 v[68:69], v12 offset:36864
    ds_read_b64_tr_b16 v[70:71], v12 offset:38400
    ds_read_b64_tr_b16 v[72:73], v12 offset:37376
    ds_read_b64_tr_b16 v[74:75], v12 offset:38912
    ds_read_b64_tr_b16 v[76:77], v12 offset:37888
    ds_read_b64_tr_b16 v[78:79], v12 offset:39424
    s_waitcnt lgkmcnt(7)
    v_mfma_f32_32x32x16_bf16 v[16:31], v[84:87], v[80:83], v[16:31]
    s_add_u32 m0, s60, 1024
    s_nop 0
    buffer_load_dwordx4 v3, s[8:11], s62 offen lds
    v_mfma_f32_32x32x16_bf16 v[32:47], v[88:91], v[80:83], v[32:47]
    v_mfma_f32_32x32x16_bf16 v[48:63], v[80:83], v[92:95], v[48:63]
    ds_read_b128 v[80:83], v11 offset:16384
    ds_read_b64_tr_b16 v[84:85], v12 offset:43008
    ds_read_b64_tr_b16 v[86:87], v12 offset:44544
    ds_read_b64_tr_b16 v[88:89], v12 offset:43520
    ds_read_b64_tr_b16 v[90:91], v12 offset:45056
    ds_read_b64_tr_b16 v[92:93], v12 offset:44032
    ds_read_b64_tr_b16 v[94:95], v12 offset:45568
    s_waitcnt lgkmcnt(7)
    v_mfma_f32_32x32x16_bf16 v[16:31], v[68:71], v[64:67], v[16:31]
    s_add_u32 m0, s61, 0
    s_nop 0
    buffer_load_dwordx4 v4, s[12:15], s63 offen lds
    v_mfma_f32_32x32x16_bf16 v[32:47], v[72:75], v[64:67], v[32:47]
    v_mfma_f32_32x32x16_bf16 v[48:63], v[64:67], v[76:79], v[48:63]
    s_waitcnt lgkmcnt(0)
    v_mfma_f32_32x32x16_bf16 v[16:31], v[84:87], v[80:83], v[16:31]
    s_add_u32 m0, s61, 1024
    s_nop 0
    buffer_load_dwordx4 v5, s[12:15], s63 offen lds
    v_mfma_f32_32x32x16_bf16 v[32:47], v[88:91], v[80:83], v[32:47]
    v_mfma_f32_32x32x16_bf16 v[48:63], v[80:83], v[92:95], v[48:63]
    s_add_u32 m0, s61, 2048
    s_nop 0
    buffer_load_dwordx4 v6, s[12:15], s63 offen lds
    s_waitcnt vmcnt(5)
    s_barrier
    ds_read_b128 v[64:67], v8 offset:32768
    ds_read_b64_tr_b16 v[68:69], v13 offset:0
    ds_read_b64_tr_b16 v[70:71], v13 offset:1536
    ds_read_b64_tr_b16 v[72:73], v13 offset:512
    ds_read_b64_tr_b16 v[74:75], v13 offset:2048
    ds_read_b64_tr_b16 v[76:77], v13 offset:1024
    ds_read_b64_tr_b16 v[78:79], v13 offset:2560
    s_mul_i32 s62, s5, 1
    s_add_u32 s62, s62, 7
    s_and_b32 s62, s62, 7
    s_mul_i32 s63, s62, 196608
    s_lshl_b32 s62, s62, 7
    ds_read_b128 v[80:83], v9 offset:32768
    ds_read_b64_tr_b16 v[84:85], v13 offset:6144
    ds_read_b64_tr_b16 v[86:87], v13 offset:7680
    ds_read_b64_tr_b16 v[88:89], v13 offset:6656
    ds_read_b64_tr_b16 v[90:91], v13 offset:8192
    ds_read_b64_tr_b16 v[92:93], v13 offset:7168
    ds_read_b64_tr_b16 v[94:95], v13 offset:8704
    s_waitcnt lgkmcnt(7)
    v_mfma_f32_32x32x16_bf16 v[16:31], v[68:71], v[64:67], v[16:31]
    s_add_u32 m0, s60, 16384
    s_nop 0
    buffer_load_dwordx4 v2, s[8:11], s62 offen lds
    v_mfma_f32_32x32x16_bf16 v[32:47], v[72:75], v[64:67], v[32:47]
    v_mfma_f32_32x32x16_bf16 v[48:63], v[64:67], v[76:79], v[48:63]
    ds_read_b128 v[64:67], v10 offset:32768
    ds_read_b64_tr_b16 v[68:69], v13 offset:12288
    ds_read_b64_tr_b16 v[70:71], v13 offset:13824
    ds_read_b64_tr_b16 v[72:73], v13 offset:12800
    ds_read_b64_tr_b16 v[74:75], v13 offset:14336
    ds_read_b64_tr_b16 v[76:77], v13 offset:13312
    ds_read_b64_tr_b16 v[78:79], v13 offset:14848
    s_waitcnt lgkmcnt(7)
    v_mfma_f32_32x32x16_bf16 v[16:31], v[84:87], v[80:83], v[16:31]
    s_add_u32 m0, s60, 17408
    s_nop 0
    buffer_load_dwordx4 v3, s[8:11], s62 offen lds
    v_mfma_f32_32x32x16_bf16 v[32:47], v[88:91], v[80:83], v[32:47]
    v_mfma_f32_32x32x16_bf16 v[48:63], v[80:83], v[92:95], v[48:63]
    ds_read_b128 v[80:83], v11 offset:32768
    ds_read_b64_tr_b16 v[84:85], v13 offset:18432
    ds_read_b64_tr_b16 v[86:87], v13 offset:19968
    ds_read_b64_tr_b16 v[88:89], v13 offset:18944
    ds_read_b64_tr_b16 v[90:91], v13 offset:20480
    ds_read_b64_tr_b16 v[92:93], v13 offset:19456
    ds_read_b64_tr_b16 v[94:95], v13 offset:20992
    s_waitcnt lgkmcnt(7)
    v_mfma_f32_32x32x16_bf16 v[16:31], v[68:71], v[64:67], v[16:31]
    s_add_u32 m0, s61, 24576
    s_nop 0
    buffer_load_dwordx4 v4, s[12:15], s63 offen lds
    v_mfma_f32_32x32x16_bf16 v[32:47], v[72:75], v[64:67], v[32:47]
    v_mfma_f32_32x32x16_bf16 v[48:63], v[64:67], v[76:79], v[48:63]
    s_waitcnt lgkmcnt(0)
    v_mfma_f32_32x32x16_bf16 v[16:31], v[84:87], v[80:83], v[16:31]
    s_add_u32 m0, s61, 25600
    s_nop 0
    buffer_load_dwordx4 v5, s[12:15], s63 offen lds
    v_mfma_f32_32x32x16_bf16 v[32:47], v[88:91], v[80:83], v[32:47]
    v_mfma_f32_32x32x16_bf16 v[48:63], v[80:83], v[92:95], v[48:63]
    s_add_u32 m0, s61, 26624
    s_nop 0
    buffer_load_dwordx4 v6, s[12:15], s63 offen lds
    s_waitcnt vmcnt(5)
    s_barrier
    ds_read_b128 v[64:67], v8 offset:0
    ds_read_b64_tr_b16 v[68:69], v12 offset:0
    ds_read_b64_tr_b16 v[70:71], v12 offset:1536
    ds_read_b64_tr_b16 v[72:73], v12 offset:512
    ds_read_b64_tr_b16 v[74:75], v12 offset:2048
    ds_read_b64_tr_b16 v[76:77], v12 offset:1024
    ds_read_b64_tr_b16 v[78:79], v12 offset:2560
    ds_read_b128 v[80:83], v9 offset:0
    ds_read_b64_tr_b16 v[84:85], v12 offset:6144
    ds_read_b64_tr_b16 v[86:87], v12 offset:7680
    ds_read_b64_tr_b16 v[88:89], v12 offset:6656
    ds_read_b64_tr_b16 v[90:91], v12 offset:8192
    ds_read_b64_tr_b16 v[92:93], v12 offset:7168
    ds_read_b64_tr_b16 v[94:95], v12 offset:8704
    s_waitcnt lgkmcnt(7)
    v_mfma_f32_32x32x16_bf16 v[16:31], v[68:71], v[64:67], v[16:31]
    v_mfma_f32_32x32x16_bf16 v[32:47], v[72:75], v[64:67], v[32:47]
    v_mfma_f32_32x32x16_bf16 v[48:63], v[64:67], v[76:79], v[48:63]
    ds_read_b128 v[64:67], v10 offset:0
    ds_read_b64_tr_b16 v[68:69], v12 offset:12288
    ds_read_b64_tr_b16 v[70:71], v12 offset:13824
    ds_read_b64_tr_b16 v[72:73], v12 offset:12800
    ds_read_b64_tr_b16 v[74:75], v12 offset:14336
    ds_read_b64_tr_b16 v[76:77], v12 offset:13312
    ds_read_b64_tr_b16 v[78:79], v12 offset:14848
    s_waitcnt lgkmcnt(7)
    v_mfma_f32_32x32x16_bf16 v[16:31], v[84:87], v[80:83], v[16:31]
    v_mfma_f32_32x32x16_bf16 v[32:47], v[88:91], v[80:83], v[32:47]
    v_mfma_f32_32x32x16_bf16 v[48:63], v[80:83], v[92:95], v[48:63]
    ds_read_b128 v[80:83], v11 offset:0
    ds_read_b64_tr_b16 v[84:85], v12 offset:18432
    ds_read_b64_tr_b16 v[86:87], v12 offset:19968
    ds_read_b64_tr_b16 v[88:89], v12 offset:18944
    ds_read_b64_tr_b16 v[90:91], v12 offset:20480
    ds_read_b64_tr_b16 v[92:93], v12 offset:19456
    ds_read_b64_tr_b16 v[94:95], v12 offset:20992
    s_waitcnt lgkmcnt(7)
    v_mfma_f32_32x32x16_bf16 v[16:31], v[68:71], v[64:67], v[16:31]
    v_mfma_f32_32x32x16_bf16 v[32:47], v[72:75], v[64:67], v[32:47]
    v_mfma_f32_32x32x16_bf16 v[48:63], v[64:67], v[76:79], v[48:63]
    s_waitcnt lgkmcnt(0)
    v_mfma_f32_32x32x16_bf16 v[16:31], v[84:87], v[80:83], v[16:31]
    v_mfma_f32_32x32x16_bf16 v[32:47], v[88:91], v[80:83], v[32:47]
    v_mfma_f32_32x32x16_bf16 v[48:63], v[80:83], v[92:95], v[48:63]
    s_cmp_lg_u32 s6, 0
    s_cbranch_scc1 k1q_noprobe
    buffer_load_dword v249, v251, s[72:75], 0 offen sc1
k1q_noprobe:
    s_waitcnt vmcnt(0)
    s_barrier
    ds_read_b128 v[64:67], v8 offset:16384
    ds_read_b64_tr_b16 v[68:69], v12 offset:24576
    ds_read_b64_tr_b16 v[70:71], v12 offset:26112
    ds_read_b64_tr_b16 v[72:73], v12 offset:25088
    ds_read_b64_tr_b16 v[74:75], v12 offset:26624
    ds_read_b64_tr_b16 v[76:77], v12 offset:25600
    ds_read_b64_tr_b16 v[78:79], v12 offset:27136
    ds_read_b128 v[80:83], v9 offset:16384
    ds_read_b64_tr_b16 v[84:85], v12 offset:30720
    ds_read_b64_tr_b16 v[86:87], v12 offset:32256
    ds_read_b64_tr_b16 v[88:89], v12 offset:31232
    ds_read_b64_tr_b16 v[90:91], v12 offset:32768
    ds_read_b64_tr_b16 v[92:93], v12 offset:31744
    ds_read_b64_tr_b16 v[94:95], v12 offset:33280
    s_waitcnt lgkmcnt(7)
    v_mfma_f32_32x32x16_bf16 v[16:31], v[68:71], v[64:67], v[16:31]
    v_mfma_f32_32x32x16_bf16 v[32:47], v[72:75], v[64:67], v[32:47]
    v_mfma_f32_32x32x16_bf16 v[48:63], v[64:67], v[76:79], v[48:63]
    ds_read_b128 v[64:67], v10 offset:16384
    ds_read_b64_tr_b16 v[68:69], v12 offset:36864
    ds_read_b64_tr_b16 v[70:71], v12 offset:38400
    ds_read_b64_tr_b16 v[72:73], v12 offset:37376
    ds_read_b64_tr_b16 v[74:75], v12 offset:38912
    ds_read_b64_tr_b16 v[76:77], v12 offset:37888
    ds_read_b64_tr_b16 v[78:79], v12 offset:39424
    s_waitcnt lgkmcnt(7)
    v_mfma_f32_32x32x16_bf16 v[16:31], v[84:87], v[80:83], v[16:31]
    v_mfma_f32_32x32x16_bf16 v[32:47], v[88:91], v[80:83], v[32:47]
    v_mfma_f32_32x32x16_bf16 v[48:63], v[80:83], v[92:95], v[48:63]
    ds_read_b128 v[80:83], v11 offset:16384
    ds_read_b64_tr_b16 v[84:85], v12 offset:43008
    ds_read_b64_tr_b16 v[86:87], v12 offset:44544
    ds_read_b64_tr_b16 v[88:89], v12 offset:43520
    ds_read_b64_tr_b16 v[90:91], v12 offset:45056
    ds_read_b64_tr_b16 v[92:93], v12 offset:44032
    ds_read_b64_tr_b16 v[94:95], v12 offset:45568
    s_waitcnt lgkmcnt(7)
    v_mfma_f32_32x32x16_bf16 v[16:31], v[68:71], v[64:67], v[16:31]
    v_mfma_f32_32x32x16_bf16 v[32:47], v[72:75], v[64:67], v[32:47]
    v_mfma_f32_32x32x16_bf16 v[48:63], v[64:67], v[76:79], v[48:63]
    s_waitcnt lgkmcnt(0)
    v_mfma_f32_32x32x16_bf16 v[16:31], v[84:87], v[80:83], v[16:31]
    v_mfma_f32_32x32x16_bf16 v[32:47], v[88:91], v[80:83], v[32:47]
    v_mfma_f32_32x32x16_bf16 v[48:63], v[80:83], v[92:95], v[48:63]
    s_barrier
    s_mov_b32 s8, s46
    s_mov_b32 s9, s47
    s_mov_b32 s10, 1409024
    s_mov_b32 s11, 0x00020000
    v_bfe_u32 v250, v1, 2, 2
    v_lshl_add_u32 v250, v15, 2, v250
    v_lshlrev_b32 v250, 10, v250
    v_bfe_u32 v252, v1, 4, 1
    v_lshl_add_u32 v250, v252, 6, v250
    v_and_b32 v252, 3, v1
    v_lshl_add_u32 v250, v252, 4, v250
    s_lshr_b32 s3, s2, 3
    s_and_b32 s3, s3, 7
    s_lshl_b32 s3, s3, 7
    v_add_u32 v250, s3, v250
    s_lshl_b32 s68, s6, 11
    s_cmp_lt_u32 s6, 2
    s_cselect_b32 s3, 8, 0
    s_sub_u32 s3, s6, s3
    s_sub_u32 s33, s3, 82
    s_sub_u32 s34, s3, 162
    s_mov_b32 s32, s6
    s_cmp_lt_u32 s6, 2
    s_cselect_b32 s35, s32, s33
    s_cselect_b32 s36, s33, s34
    s_lshl_b32 s32, s32, 14
    s_lshl_b32 s33, s33, 14
    s_lshl_b32 s34, s34, 14
    s_lshl_b32 s35, s35, 14
    s_lshl_b32 s36, s36, 14
    s_add_u32 s16, s56, 12713984
    s_addc_u32 s17, s57, 0
    s_mov_b32 s18, 8192
    s_mov_b32 s19, 0x00020000
    s_and_b32 s3, s2, 7
    s_lshr_b32 s59, s2, 6
    s_lshl_b32 s60, s3, 2
    s_add_u32 s60, s60, s59
    s_mul_i32 s60, s60, 256
    v_lshl_add_u32 v244, v1, 2, s60
    v_mov_b32 v245, 8
    v_mov_b32 v247, 128
    v_cmp_eq_u32 vcc, 4, v1
    s_nop 1
    v_cndmask_b32 v245, v245, v247, vcc
    v_mov_b32 v9, 155648
    v_mov_b32 v10, 1
    s_cmp_ge_u32 s6, 4
    s_cbranch_scc1 k1q_noearly
    s_add_u32 s76, s32, 0
    s_add_u32 m0, s68, 65536
    s_nop 0
    buffer_load_dwordx4 v250, s[8:11], s76 offen lds
    s_add_u32 s76, s76, 8192
    s_add_u32 m0, s68, 66560
    s_nop 0
    buffer_load_dwordx4 v250, s[8:11], s76 offen lds
    s_add_u32 s76, s32, 196608
    s_add_u32 m0, s68, 73728
    s_nop 0
    buffer_load_dwordx4 v250, s[8:11], s76 offen lds
    s_add_u32 s76, s76, 8192
    s_add_u32 m0, s68, 74752
    s_nop 0
    buffer_load_dwordx4 v250, s[8:11], s76 offen lds
    s_add_u32 s76, s32, 393216
    s_add_u32 m0, s68, 81920
    s_nop 0
    buffer_load_dwordx4 v250, s[8:11], s76 offen lds
    s_add_u32 s76, s76, 8192
    s_add_u32 m0, s68, 82944
    s_nop 0
    buffer_load_dwordx4 v250, s[8:11], s76 offen lds
    s_add_u32 s76, s32, 589824
    s_add_u32 m0, s68, 90112
    s_nop 0
    buffer_load_dwordx4 v250, s[8:11], s76 offen lds
    s_add_u32 s76, s76, 8192
    s_add_u32 m0, s68, 91136
    s_nop 0
    buffer_load_dwordx4 v250, s[8:11], s76 offen lds
    s_add_u32 s76, s32, 786432
    s_add_u32 m0, s68, 98304
    s_nop 0
    buffer_load_dwordx4 v250, s[8:11], s76 offen lds
    s_add_u32 s76, s76, 8192
    s_add_u32 m0, s68, 99328
    s_nop 0
    buffer_load_dwordx4 v250, s[8:11], s76 offen lds
    s_add_u32 s76, s32, 983040
    s_add_u32 m0, s68, 106496
    s_nop 0
    buffer_load_dwordx4 v250, s[8:11], s76 offen lds
    s_add_u32 s76, s76, 8192
    s_add_u32 m0, s68, 107520
    s_nop 0
    buffer_load_dwordx4 v250, s[8:11], s76 offen lds
    s_add_u32 s76, s32, 1179648
    s_add_u32 m0, s68, 114688
    s_nop 0
    buffer_load_dwordx4 v250, s[8:11], s76 offen lds
    s_add_u32 s76, s76, 8192
    s_add_u32 m0, s68, 115712
    s_nop 0
    buffer_load_dwordx4 v250, s[8:11], s76 offen lds
    s_add_u32 s76, s35, 1376256
    s_add_u32 m0, s68, 122880
    s_nop 0
    buffer_load_dwordx4 v250, s[8:11], s76 offen lds
    s_add_u32 s76, s76, 8192
    s_add_u32 m0, s68, 123904
    s_nop 0
    buffer_load_dwordx4 v250, s[8:11], s76 offen lds
    s_add_u32 s76, s33, 1572864
    s_add_u32 m0, s68, 131072
    s_nop 0
    buffer_load_dwordx4 v250, s[8:11], s76 offen lds
    s_add_u32 s76, s76, 8192
    s_add_u32 m0, s68, 132096
    s_nop 0
    buffer_load_dwordx4 v250, s[8:11], s76 offen lds
    s_add_u32 s76, s33, 1769472
    s_add_u32 m0, s68, 139264
    s_nop 0
    buffer_load_dwordx4 v250, s[8:11], s76 offen lds
    s_add_u32 s76, s76, 8192
    s_add_u32 m0, s68, 140288
    s_nop 0
    buffer_load_dwordx4 v250, s[8:11], s76 offen lds
    s_add_u32 s76, s33, 1966080
    s_add_u32 m0, s68, 147456
    s_nop 0
    buffer_load_dwordx4 v250, s[8:11], s76 offen lds
    s_add_u32 s76, s76, 8192
    s_add_u32 m0, s68, 148480
    s_nop 0
    buffer_load_dwordx4 v250, s[8:11], s76 offen lds
    s_cmp_lg_u32 s6, 0
    s_cbranch_scc1 k1q_noearly
    v_cmp_ne_u32 vcc, 0, v249
    s_nop 0
    s_cmp_eq_u64 vcc, -1
    s_cbranch_scc1 k1q_noearly
    s_mov_b32 s79, 0
pl_k1q_init:
    buffer_load_dword v249, v251, s[72:75], 0 offen sc1
    s_waitcnt vmcnt(0)
    v_cmp_ne_u32 vcc, 0, v249
    s_nop 0
    s_cmp_eq_u64 vcc, -1
    s_cbranch_scc1 pd_k1q_init
    s_add_u32 s79, s79, 1
    s_cmp_lt_u32 s79, 65536
    s_cbranch_scc0 pd_k1q_init
    s_sleep 1
    s_branch pl_k1q_init
pd_k1q_init:
k1q_noearly:
    s_nop 7
    s_nop 7
    s_mov_b32 s65, 1069066811
    v_cmp_gt_u32 vcc, 16, v7
    v_lshl_or_b32 v112, v149, 16, v148
    v_lshl_or_b32 v113, v151, 16, v150
    v_lshl_or_b32 v114, v153, 16, v152
    v_lshl_or_b32 v115, v155, 16, v154
    v_cndmask_b32 v116, 0, v112, vcc
    v_cndmask_b32 v120, v112, 0, vcc
    v_cndmask_b32 v117, 0, v113, vcc
    v_cndmask_b32 v121, v113, 0, vcc
    v_cndmask_b32 v118, 0, v114, vcc
    v_cndmask_b32 v122, v114, 0, vcc
    v_cndmask_b32 v119, 0, v115, vcc
    v_cndmask_b32 v123, v115, 0, vcc
    v_lshl_or_b32 v112, v141, 16, v140
    v_lshl_or_b32 v113, v143, 16, v142
    v_lshl_or_b32 v114, v145, 16, v144
    v_lshl_or_b32 v115, v147, 16, v146
    v_cndmask_b32 v236, 0, v112, vcc
    v_cndmask_b32 v240, v112, 0, vcc
    v_cndmask_b32 v237, 0, v113, vcc
    v_cndmask_b32 v241, v113, 0, vcc
    v_cndmask_b32 v238, 0, v114, vcc
    v_cndmask_b32 v242, v114, 0, vcc
    v_cndmask_b32 v239, 0, v115, vcc
    v_cndmask_b32 v243, v115, 0, vcc
    s_nop 7
    s_nop 7
    v_cvt_pk_bf16_f32 v132, v32, v33
    v_cvt_pk_bf16_f32 v133, v34, v35
    v_cvt_pk_bf16_f32 v134, v36, v37
    v_cvt_pk_bf16_f32 v135, v38, v39
    v_cvt_pk_bf16_f32 v136, v40, v41
    v_cvt_pk_bf16_f32 v137, v42, v43
    v_cvt_pk_bf16_f32 v138, v44, v45
    v_cvt_pk_bf16_f32 v139, v46, v47
    v_mfma_f32_32x32x16_bf16 v[140:155], v[236:239], v[132:135], 0
    s_nop 0
    v_mfma_f32_32x32x16_bf16 v[140:155], v[240:243], v[136:139], v[140:155]
    s_nop 7
    s_nop 3
    v_max3_f32 v176, v140, v141, v142
    v_max3_f32 v177, -v140, -v141, -v142
    v_max3_f32 v176, v176, v143, v144
    v_max3_f32 v177, v177, -v143, -v144
    v_max3_f32 v176, v176, v145, v146
    v_max3_f32 v177, v177, -v145, -v146
    v_max_f32 v176, v176, v147
    v_max_f32_e64 v177, v177, -v147
    s_nop 1
    v_permlane32_swap_b32 v176, v177
    v_max_f32 v178, v176, v177
    v_mul_f32 v178, s65, v178
    v_mov_b32 v179, v178
    s_nop 1
    v_permlane32_swap_b32 v178, v179
    v_fma_f32 v180, v140, s65, -v178
    v_fma_f32 v188, -v140, s65, -v179
    v_fma_f32 v181, v141, s65, -v178
    v_fma_f32 v189, -v141, s65, -v179
    v_fma_f32 v182, v142, s65, -v178
    v_fma_f32 v190, -v142, s65, -v179
    v_fma_f32 v183, v143, s65, -v178
    v_fma_f32 v191, -v143, s65, -v179
    v_fma_f32 v184, v144, s65, -v178
    v_fma_f32 v192, -v144, s65, -v179
    v_fma_f32 v185, v145, s65, -v178
    v_fma_f32 v193, -v145, s65, -v179
    v_fma_f32 v186, v146, s65, -v178
    v_fma_f32 v194, -v146, s65, -v179
    v_fma_f32 v187, v147, s65, -v178
    v_fma_f32 v195, -v147, s65, -v179
    v_exp_f32 v180, v180
    v_exp_f32 v188, v188
    v_exp_f32 v181, v181
    v_exp_f32 v189, v189
    v_exp_f32 v182, v182
    v_exp_f32 v190, v190
    v_exp_f32 v183, v183
    v_exp_f32 v191, v191
    v_exp_f32 v184, v184
    v_exp_f32 v192, v192
    v_exp_f32 v185, v185
    v_exp_f32 v193, v193
    v_exp_f32 v186, v186
    v_exp_f32 v194, v194
    v_exp_f32 v187, v187
    v_exp_f32 v195, v195
    v_add_f32 v176, v180, v181
    v_add_f32 v177, v188, v189
    v_add_f32 v176, v176, v182
    v_add_f32 v177, v177, v190
    v_add_f32 v176, v176, v183
    v_add_f32 v177, v177, v191
    v_add_f32 v176, v176, v184
    v_add_f32 v177, v177, v192
    v_add_f32 v176, v176, v185
    v_add_f32 v177, v177, v193
    v_add_f32 v176, v176, v186
    v_add_f32 v177, v177, v194
    v_add_f32 v176, v176, v187
    v_add_f32 v177, v177, v195
    s_nop 1
    v_permlane32_swap_b32 v176, v177
    v_add_f32 v178, v176, v177
    v_rcp_f32 v178, v178
    s_nop 0
    v_mov_b32 v179, v178
    s_nop 1
    v_permlane32_swap_b32 v178, v179
    v_mul_f32 v180, v180, v178
    v_mul_f32 v188, v188, v179
    v_mul_f32 v181, v181, v178
    v_mul_f32 v189, v189, v179
    v_mul_f32 v182, v182, v178
    v_mul_f32 v190, v190, v179
    v_mul_f32 v183, v183, v178
    v_mul_f32 v191, v191, v179
    v_mul_f32 v184, v184, v178
    v_mul_f32 v192, v192, v179
    v_mul_f32 v185, v185, v178
    v_mul_f32 v193, v193, v179
    v_mul_f32 v186, v186, v178
    v_mul_f32 v194, v194, v179
    v_mul_f32 v187, v187, v178
    v_mul_f32 v195, v195, v179
    v_cvt_pk_bf16_f32 v220, v180, v181
    v_cvt_pk_bf16_f32 v224, v188, v189
    v_cvt_pk_bf16_f32 v221, v182, v183
    v_cvt_pk_bf16_f32 v225, v190, v191
    v_cvt_pk_bf16_f32 v222, v184, v185
    v_cvt_pk_bf16_f32 v226, v192, v193
    v_cvt_pk_bf16_f32 v223, v186, v187
    v_cvt_pk_bf16_f32 v227, v194, v195
    v_max3_f32 v196, v148, v149, v150
    v_max3_f32 v197, -v148, -v149, -v150
    v_max3_f32 v196, v196, v151, v152
    v_max3_f32 v197, v197, -v151, -v152
    v_max3_f32 v196, v196, v153, v154
    v_max3_f32 v197, v197, -v153, -v154
    v_max_f32 v196, v196, v155
    v_max_f32_e64 v197, v197, -v155
    s_nop 1
    v_permlane32_swap_b32 v196, v197
    v_max_f32 v198, v196, v197
    v_mul_f32 v198, s65, v198
    v_mov_b32 v199, v198
    s_nop 1
    v_permlane32_swap_b32 v198, v199
    v_fma_f32 v200, v148, s65, -v198
    v_fma_f32 v208, -v148, s65, -v199
    v_fma_f32 v201, v149, s65, -v198
    v_fma_f32 v209, -v149, s65, -v199
    v_fma_f32 v202, v150, s65, -v198
    v_fma_f32 v210, -v150, s65, -v199
    v_fma_f32 v203, v151, s65, -v198
    v_fma_f32 v211, -v151, s65, -v199
    v_fma_f32 v204, v152, s65, -v198
    v_fma_f32 v212, -v152, s65, -v199
    v_fma_f32 v205, v153, s65, -v198
    v_fma_f32 v213, -v153, s65, -v199
    v_fma_f32 v206, v154, s65, -v198
    v_fma_f32 v214, -v154, s65, -v199
    v_fma_f32 v207, v155, s65, -v198
    v_fma_f32 v215, -v155, s65, -v199
    v_exp_f32 v200, v200
    v_exp_f32 v208, v208
    v_exp_f32 v201, v201
    v_exp_f32 v209, v209
    v_exp_f32 v202, v202
    v_exp_f32 v210, v210
    v_exp_f32 v203, v203
    v_exp_f32 v211, v211
    v_exp_f32 v204, v204
    v_exp_f32 v212, v212
    v_exp_f32 v205, v205
    v_exp_f32 v213, v213
    v_exp_f32 v206, v206
    v_exp_f32 v214, v214
    v_exp_f32 v207, v207
    v_exp_f32 v215, v215
    v_add_f32 v196, v200, v201
    v_add_f32 v197, v208, v209
    v_add_f32 v196, v196, v202
    v_add_f32 v197, v197, v210
    v_add_f32 v196, v196, v203
    v_add_f32 v197, v197, v211
    v_add_f32 v196, v196, v204
    v_add_f32 v197, v197, v212
    v_add_f32 v196, v196, v205
    v_add_f32 v197, v197, v213
    v_add_f32 v196, v196, v206
    v_add_f32 v197, v197, v214
    v_add_f32 v196, v196, v207
    v_add_f32 v197, v197, v215
    s_nop 1
    v_permlane32_swap_b32 v196, v197
    v_add_f32 v198, v196, v197
    v_rcp_f32 v198, v198
    s_nop 0
    v_mov_b32 v199, v198
    s_nop 1
    v_permlane32_swap_b32 v198, v199
    v_mul_f32 v200, v200, v198
    v_mul_f32 v208, v208, v199
    v_mul_f32 v201, v201, v198
    v_mul_f32 v209, v209, v199
    v_mul_f32 v202, v202, v198
    v_mul_f32 v210, v210, v199
    v_mul_f32 v203, v203, v198
    v_mul_f32 v211, v211, v199
    v_mul_f32 v204, v204, v198
    v_mul_f32 v212, v212, v199
    v_mul_f32 v205, v205, v198
    v_mul_f32 v213, v213, v199
    v_mul_f32 v206, v206, v198
    v_mul_f32 v214, v214, v199
    v_mul_f32 v207, v207, v198
    v_mul_f32 v215, v215, v199
    v_cvt_pk_bf16_f32 v228, v200, v201
    v_cvt_pk_bf16_f32 v232, v208, v209
    v_cvt_pk_bf16_f32 v229, v202, v203
    v_cvt_pk_bf16_f32 v233, v210, v211
    v_cvt_pk_bf16_f32 v230, v204, v205
    v_cvt_pk_bf16_f32 v234, v212, v213
    v_cvt_pk_bf16_f32 v231, v206, v207
    v_cvt_pk_bf16_f32 v235, v214, v215
    v_mfma_f32_32x32x16_bf16 v[80:95], v[220:223], v[124:127], 0
    v_mfma_f32_32x32x16_bf16 v[96:111], v[228:231], v[124:127], 0
    v_mfma_f32_32x32x16_bf16 v[80:95], v[224:227], v[128:131], v[80:95]
    v_mfma_f32_32x32x16_bf16 v[96:111], v[232:235], v[128:131], v[96:111]
    v_cvt_pk_bf16_f32 v132, v48, v49
    v_cvt_pk_bf16_f32 v133, v50, v51
    v_cvt_pk_bf16_f32 v134, v52, v53
    v_cvt_pk_bf16_f32 v135, v54, v55
    v_cvt_pk_bf16_f32 v136, v56, v57
    v_cvt_pk_bf16_f32 v137, v58, v59
    v_cvt_pk_bf16_f32 v138, v60, v61
    v_cvt_pk_bf16_f32 v139, v62, v63
    v_cmp_gt_u32 vcc, 16, v7
    v_mov_b32 v156, s64
    s_nop 0
    v_cndmask_b32 v140, v156, v132, vcc
    v_cndmask_b32 v148, v132, v156, vcc
    v_cndmask_b32 v141, v156, v133, vcc
    v_cndmask_b32 v149, v133, v156, vcc
    v_cndmask_b32 v142, v156, v134, vcc
    v_cndmask_b32 v150, v134, v156, vcc
    v_cndmask_b32 v143, v156, v135, vcc
    v_cndmask_b32 v151, v135, v156, vcc
    v_cndmask_b32 v144, v156, v136, vcc
    v_cndmask_b32 v152, v136, v156, vcc
    v_cndmask_b32 v145, v156, v137, vcc
    v_cndmask_b32 v153, v137, v156, vcc
    v_cndmask_b32 v146, v156, v138, vcc
    v_cndmask_b32 v154, v138, v156, vcc
    v_cndmask_b32 v147, v156, v139, vcc
    v_cndmask_b32 v155, v139, v156, vcc
    v_cvt_pk_bf16_f32 v176, v80, v81
    v_cvt_pk_bf16_f32 v177, v82, v83
    v_cvt_pk_bf16_f32 v178, v84, v85
    v_cvt_pk_bf16_f32 v179, v86, v87
    v_cvt_pk_bf16_f32 v180, v88, v89
    v_cvt_pk_bf16_f32 v181, v90, v91
    v_cvt_pk_bf16_f32 v182, v92, v93
    v_cvt_pk_bf16_f32 v183, v94, v95
    v_cvt_pk_bf16_f32 v184, v96, v97
    v_cvt_pk_bf16_f32 v185, v98, v99
    v_cvt_pk_bf16_f32 v186, v100, v101
    v_cvt_pk_bf16_f32 v187, v102, v103
    v_cvt_pk_bf16_f32 v188, v104, v105
    v_cvt_pk_bf16_f32 v189, v106, v107
    v_cvt_pk_bf16_f32 v190, v108, v109
    v_cvt_pk_bf16_f32 v191, v110, v111
    v_mfma_f32_32x32x16_bf16 v[48:63], v[176:179], v[140:143], 0
    v_mfma_f32_32x32x16_bf16 v[64:79], v[184:187], v[148:151], 0
    v_mfma_f32_32x32x16_bf16 v[48:63], v[180:183], v[144:147], v[48:63]
    v_mfma_f32_32x32x16_bf16 v[64:79], v[188:191], v[152:155], v[64:79]
    s_lshl_b32 s3, s6, 13
    v_lshlrev_b32 v216, 4, v1
    v_add_u32 v217, s3, v216
    s_nop 7
    ds_write_b128 v217, v[48:51] offset:0
    ds_write_b128 v217, v[52:55] offset:1024
    ds_write_b128 v217, v[56:59] offset:2048
    ds_write_b128 v217, v[60:63] offset:3072
    ds_write_b128 v217, v[64:67] offset:4096
    ds_write_b128 v217, v[68:71] offset:5120
    ds_write_b128 v217, v[72:75] offset:6144
    ds_write_b128 v217, v[76:79] offset:7168
    s_waitcnt lgkmcnt(0)
    s_barrier
    s_lshr_b32 s60, s7, 1
    s_and_b32 s61, s7, 1
    s_lshl_b32 s61, s61, 1
    s_lshl_b32 s3, s58, 15
    s_mul_i32 s59, s60, 4352
    s_add_u32 s3, s3, s59
    s_lshl_b32 s59, s61, 10
    s_add_u32 s3, s3, s59
    v_lshlrev_b32 v218, 2, v1
    v_add_u32 v217, s3, v218
    ds_read_b32 v132, v217 offset:0
    ds_read_b32 v133, v217 offset:8192
    ds_read_b32 v134, v217 offset:16384
    ds_read_b32 v135, v217 offset:24576
    ds_read_b32 v136, v217 offset:512
    ds_read_b32 v137, v217 offset:8704
    ds_read_b32 v138, v217 offset:16896
    ds_read_b32 v139, v217 offset:25088
    ds_read_b32 v140, v217 offset:1024
    ds_read_b32 v141, v217 offset:9216
    ds_read_b32 v142, v217 offset:17408
    ds_read_b32 v143, v217 offset:25600
    ds_read_b32 v144, v217 offset:1536
    ds_read_b32 v145, v217 offset:9728
    ds_read_b32 v146, v217 offset:17920
    ds_read_b32 v147, v217 offset:26112
    s_lshl_b32 s59, s60, 9
    s_sub_u32 s3, s3, s59
    s_add_u32 s3, s3, 256
    v_and_b32 v219, 15, v1
    v_lshrrev_b32 v215, 2, v219
    v_and_b32 v214, 3, v1
    v_lshlrev_b32 v214, 2, v214
    v_lshl_add_u32 v219, v215, 9, v214
    v_add_u32 v217, s3, v219
    ds_read_b32 v148, v217 offset:0
    ds_read_b32 v149, v217 offset:8192
    ds_read_b32 v150, v217 offset:16384
    ds_read_b32 v151, v217 offset:24576
    s_lshl_b32 s3, s5, 2
    s_lshl_b32 s59, s58, 1
    s_add_u32 s3, s3, s59
    s_add_u32 s3, s3, s60
    s_lshl_b32 s3, s3, 2
    s_add_u32 s3, s3, s61
    s_lshl_b32 s3, s3, 10
    s_waitcnt lgkmcnt(0)
    v_add_f32 v132, v132, v133
    v_add_f32 v134, v134, v135
    v_add_f32 v136, v136, v137
    v_add_f32 v138, v138, v139
    v_add_f32 v140, v140, v141
    v_add_f32 v142, v142, v143
    v_add_f32 v144, v144, v145
    v_add_f32 v146, v146, v147
    v_add_f32 v148, v148, v149
    v_add_f32 v150, v150, v151
    v_add_f32 v80, v132, v134
    v_add_f32 v81, v136, v138
    v_add_f32 v82, v140, v142
    v_add_f32 v83, v144, v146
    v_add_f32 v84, v148, v150
    s_barrier
    buffer_atomic_add_f32 v80, v218, s[28:31], s3 offen offset:0
    buffer_atomic_add_f32 v81, v218, s[28:31], s3 offen offset:512
    buffer_atomic_add_f32 v82, v218, s[28:31], s3 offen offset:1024
    buffer_atomic_add_f32 v83, v218, s[28:31], s3 offen offset:1536
    s_mov_b64 exec, 0xffff
    buffer_atomic_add_f32 v84, v219, s[28:31], s3 offen offset:256
    s_mov_b64 exec, -1
    v_mov_b32 v246, 0
    v_cvt_pk_bf16_f32 v132, v16, v17
    v_cvt_pk_bf16_f32 v133, v18, v19
    v_cvt_pk_bf16_f32 v134, v20, v21
    v_cvt_pk_bf16_f32 v135, v22, v23
    v_cvt_pk_bf16_f32 v136, v24, v25
    v_cvt_pk_bf16_f32 v137, v26, v27
    v_cvt_pk_bf16_f32 v138, v28, v29
    v_cvt_pk_bf16_f32 v139, v30, v31
    v_mfma_f32_32x32x16_bf16 v[140:155], v[116:119], v[132:135], 0
    s_nop 0
    v_mfma_f32_32x32x16_bf16 v[140:155], v[120:123], v[136:139], v[140:155]
    s_nop 7
    s_nop 3
    v_max3_f32 v176, v140, v141, v142
    v_max3_f32 v177, -v140, -v141, -v142
    v_max3_f32 v176, v176, v143, v144
    v_max3_f32 v177, v177, -v143, -v144
    v_max3_f32 v176, v176, v145, v146
    v_max3_f32 v177, v177, -v145, -v146
    v_max_f32 v176, v176, v147
    v_max_f32_e64 v177, v177, -v147
    s_nop 1
    v_permlane32_swap_b32 v176, v177
    v_max_f32 v178, v176, v177
    v_mul_f32 v178, s65, v178
    v_mov_b32 v179, v178
    s_nop 1
    v_permlane32_swap_b32 v178, v179
    v_fma_f32 v180, v140, s65, -v178
    v_fma_f32 v188, -v140, s65, -v179
    v_fma_f32 v181, v141, s65, -v178
    v_fma_f32 v189, -v141, s65, -v179
    v_fma_f32 v182, v142, s65, -v178
    v_fma_f32 v190, -v142, s65, -v179
    v_fma_f32 v183, v143, s65, -v178
    v_fma_f32 v191, -v143, s65, -v179
    v_fma_f32 v184, v144, s65, -v178
    v_fma_f32 v192, -v144, s65, -v179
    v_fma_f32 v185, v145, s65, -v178
    v_fma_f32 v193, -v145, s65, -v179
    v_fma_f32 v186, v146, s65, -v178
    v_fma_f32 v194, -v146, s65, -v179
    v_fma_f32 v187, v147, s65, -v178
    v_fma_f32 v195, -v147, s65, -v179
    v_exp_f32 v180, v180
    v_exp_f32 v188, v188
    v_exp_f32 v181, v181
    v_exp_f32 v189, v189
    v_exp_f32 v182, v182
    v_exp_f32 v190, v190
    v_exp_f32 v183, v183
    v_exp_f32 v191, v191
    v_exp_f32 v184, v184
    v_exp_f32 v192, v192
    v_exp_f32 v185, v185
    v_exp_f32 v193, v193
    v_exp_f32 v186, v186
    v_exp_f32 v194, v194
    v_exp_f32 v187, v187
    v_exp_f32 v195, v195
    v_add_f32 v176, v180, v181
    v_add_f32 v177, v188, v189
    v_add_f32 v176, v176, v182
    v_add_f32 v177, v177, v190
    v_add_f32 v176, v176, v183
    v_add_f32 v177, v177, v191
    v_add_f32 v176, v176, v184
    v_add_f32 v177, v177, v192
    v_add_f32 v176, v176, v185
    v_add_f32 v177, v177, v193
    v_add_f32 v176, v176, v186
    v_add_f32 v177, v177, v194
    v_add_f32 v176, v176, v187
    v_add_f32 v177, v177, v195
    s_nop 1
    v_permlane32_swap_b32 v176, v177
    v_add_f32 v178, v176, v177
    v_rcp_f32 v178, v178
    s_nop 0
    v_mov_b32 v179, v178
    s_nop 1
    v_permlane32_swap_b32 v178, v179
    v_mul_f32 v180, v180, v178
    v_mul_f32 v188, v188, v179
    v_mul_f32 v181, v181, v178
    v_mul_f32 v189, v189, v179
    v_mul_f32 v182, v182, v178
    v_mul_f32 v190, v190, v179
    v_mul_f32 v183, v183, v178
    v_mul_f32 v191, v191, v179
    v_mul_f32 v184, v184, v178
    v_mul_f32 v192, v192, v179
    v_mul_f32 v185, v185, v178
    v_mul_f32 v193, v193, v179
    v_mul_f32 v186, v186, v178
    v_mul_f32 v194, v194, v179
    v_mul_f32 v187, v187, v178
    v_mul_f32 v195, v195, v179
    v_cvt_pk_bf16_f32 v160, v180, v181
    v_cvt_pk_bf16_f32 v164, v188, v189
    v_cvt_pk_bf16_f32 v161, v182, v183
    v_cvt_pk_bf16_f32 v165, v190, v191
    v_cvt_pk_bf16_f32 v162, v184, v185
    v_cvt_pk_bf16_f32 v166, v192, v193
    v_cvt_pk_bf16_f32 v163, v186, v187
    v_cvt_pk_bf16_f32 v167, v194, v195
    v_max3_f32 v196, v148, v149, v150
    v_max3_f32 v197, -v148, -v149, -v150
    v_max3_f32 v196, v196, v151, v152
    v_max3_f32 v197, v197, -v151, -v152
    v_max3_f32 v196, v196, v153, v154
    v_max3_f32 v197, v197, -v153, -v154
    v_max_f32 v196, v196, v155
    v_max_f32_e64 v197, v197, -v155
    s_nop 1
    v_permlane32_swap_b32 v196, v197
    v_max_f32 v198, v196, v197
    v_mul_f32 v198, s65, v198
    v_mov_b32 v199, v198
    s_nop 1
    v_permlane32_swap_b32 v198, v199
    v_fma_f32 v200, v148, s65, -v198
    v_fma_f32 v208, -v148, s65, -v199
    v_fma_f32 v201, v149, s65, -v198
    v_fma_f32 v209, -v149, s65, -v199
    v_fma_f32 v202, v150, s65, -v198
    v_fma_f32 v210, -v150, s65, -v199
    v_fma_f32 v203, v151, s65, -v198
    v_fma_f32 v211, -v151, s65, -v199
    v_fma_f32 v204, v152, s65, -v198
    v_fma_f32 v212, -v152, s65, -v199
    v_fma_f32 v205, v153, s65, -v198
    v_fma_f32 v213, -v153, s65, -v199
    v_fma_f32 v206, v154, s65, -v198
    v_fma_f32 v214, -v154, s65, -v199
    v_fma_f32 v207, v155, s65, -v198
    v_fma_f32 v215, -v155, s65, -v199
    v_exp_f32 v200, v200
    v_exp_f32 v208, v208
    v_exp_f32 v201, v201
    v_exp_f32 v209, v209
    v_exp_f32 v202, v202
    v_exp_f32 v210, v210
    v_exp_f32 v203, v203
    v_exp_f32 v211, v211
    v_exp_f32 v204, v204
    v_exp_f32 v212, v212
    v_exp_f32 v205, v205
    v_exp_f32 v213, v213
    v_exp_f32 v206, v206
    v_exp_f32 v214, v214
    v_exp_f32 v207, v207
    v_exp_f32 v215, v215
    v_add_f32 v196, v200, v201
    v_add_f32 v197, v208, v209
    v_add_f32 v196, v196, v202
    v_add_f32 v197, v197, v210
    v_add_f32 v196, v196, v203
    v_add_f32 v197, v197, v211
    v_add_f32 v196, v196, v204
    v_add_f32 v197, v197, v212
    v_add_f32 v196, v196, v205
    v_add_f32 v197, v197, v213
    v_add_f32 v196, v196, v206
    v_add_f32 v197, v197, v214
    v_add_f32 v196, v196, v207
    v_add_f32 v197, v197, v215
    s_nop 1
    v_permlane32_swap_b32 v196, v197
    v_add_f32 v198, v196, v197
    v_rcp_f32 v198, v198
    s_nop 0
    v_mov_b32 v199, v198
    s_nop 1
    v_permlane32_swap_b32 v198, v199
    v_mul_f32 v200, v200, v198
    v_mul_f32 v208, v208, v199
    v_mul_f32 v201, v201, v198
    v_mul_f32 v209, v209, v199
    v_mul_f32 v202, v202, v198
    v_mul_f32 v210, v210, v199
    v_mul_f32 v203, v203, v198
    v_mul_f32 v211, v211, v199
    v_mul_f32 v204, v204, v198
    v_mul_f32 v212, v212, v199
    v_mul_f32 v205, v205, v198
    v_mul_f32 v213, v213, v199
    v_mul_f32 v206, v206, v198
    v_mul_f32 v214, v214, v199
    v_mul_f32 v207, v207, v198
    v_mul_f32 v215, v215, v199
    v_cvt_pk_bf16_f32 v168, v200, v201
    v_cvt_pk_bf16_f32 v172, v208, v209
    v_cvt_pk_bf16_f32 v169, v202, v203
    v_cvt_pk_bf16_f32 v173, v210, v211
    v_cvt_pk_bf16_f32 v170, v204, v205
    v_cvt_pk_bf16_f32 v174, v212, v213
    v_cvt_pk_bf16_f32 v171, v206, v207
    v_cvt_pk_bf16_f32 v175, v214, v215
    s_lshl_b32 s3, s6, 12
    v_add_u32 v217, s3, v216
    ds_write_b128 v217, v[160:163] offset:0
    ds_write_b128 v217, v[164:167] offset:1024
    ds_write_b128 v217, v[168:171] offset:2048
    ds_write_b128 v217, v[172:175] offset:3072
    s_waitcnt vmcnt(0)
    s_mov_b64 exec, 1
    v_mov_b32 v252, 155664
    v_mov_b32 v253, 1
    ds_add_rtn_u32 v254, v252, v253
    s_waitcnt lgkmcnt(0)
    v_readfirstlane_b32 s3, v254
    s_nop 0
    s_cmp_lg_u32 s3, 7
    s_cbranch_scc1 sg_kv
    s_mov_b64 exec, 0xffffffff
    s_mov_b32 s3, 16
    v_mul_u32_u24 v252, 256, v1
    v_mov_b32 v253, 1
    buffer_atomic_add v253, v252, s[16:19], s3 offen
sg_kv:
    s_mov_b64 exec, -1
    s_mov_b64 exec, 1
    v_mov_b32 v252, 155672
    v_mov_b32 v253, 1
    ds_add_u32 v252, v253
    s_mov_b64 exec, -1
    s_cmp_lg_u32 s6, 5
    s_cbranch_scc1 q_notm
    s_mov_b32 s60, 0
    s_mov_b64 exec, 0x1f
    v_mov_b32 v246, 0
    buffer_atomic_add v246, v244, s[16:19], 0 offen sc0
    s_branch helper
q_notm:
    s_cmp_lt_u32 s6, 4
    s_cbranch_scc1 phase2
    s_cmp_eq_u32 s6, 4
    s_cbranch_scc1 os_end
    v_mov_b32 v9, 155648
    v_lshlrev_b32 v14, 4, v1
    v_and_b32 v2, 15, v1
    v_lshlrev_b32 v2, 4, v2
    v_mov_b32 v5, 256
    v_cmp_gt_u32 vcc, 16, v7
    s_nop 1
    v_cndmask_b32 v3, v5, v2, vcc
    v_cndmask_b32 v4, v2, v5, vcc
    v_lshl_add_u32 v3, v15, 9, v3
    v_lshl_add_u32 v4, v15, 9, v4
    s_xor_b32 s60, s5, 1
    s_lshl_b32 s60, s60, 2
    s_lshl_b32 s61, s60, 12
    s_lshl_b32 s62, s4, 7
    s_add_u32 s62, s62, s60
    s_lshl_b32 s62, s62, 10
    s_mov_b32 s79, 0
os_w:
    ds_read_b32 v6, v9 offset:24
    s_waitcnt lgkmcnt(0)
    v_readfirstlane_b32 s78, v6
    s_nop 0
    s_cmp_ge_u32 s78, 8
    s_cbranch_scc1 os_d
    s_add_u32 s79, s79, 1
    s_cmp_lt_u32 s79, 524288
    s_cbranch_scc0 os_d
    s_sleep 1
    s_branch os_w
os_d:
    s_mov_b32 s79, 0
lw_okv:
    ds_read_b32 v6, v9 offset:28
    s_waitcnt lgkmcnt(0)
    v_readfirstlane_b32 s78, v6
    s_nop 0
    s_cmp_lg_u32 s78, 0
    s_cbranch_scc1 ld_okv
    s_add_u32 s79, s79, 1
    s_cmp_lt_u32 s79, 524288
    s_cbranch_scc0 ld_okv
    s_sleep 1
    s_branch lw_okv
ld_okv:
    s_sub_u32 s63, s6, 6
    s_lshl_b32 s63, s63, 13
    s_add_u32 s61, s61, s63
    s_add_u32 s63, s61, 0
    buffer_load_dwordx4 v[80:83], v3, s[28:31], s63 offen offset:0 sc1
    buffer_load_dwordx4 v[84:87], v3, s[28:31], s63 offen offset:1024 sc1
    buffer_load_dwordx4 v[88:91], v3, s[28:31], s63 offen offset:2048 sc1
    buffer_load_dwordx4 v[92:95], v3, s[28:31], s63 offen offset:3072 sc1
    s_add_u32 s63, s61, 4096
    buffer_load_dwordx4 v[96:99], v4, s[28:31], s63 offen offset:0 sc1
    buffer_load_dwordx4 v[100:103], v4, s[28:31], s63 offen offset:1024 sc1
    buffer_load_dwordx4 v[104:107], v4, s[28:31], s63 offen offset:2048 sc1
    buffer_load_dwordx4 v[108:111], v4, s[28:31], s63 offen offset:3072 sc1
    s_waitcnt vmcnt(4)
    v_cvt_pk_bf16_f32 v144, v80, v81
    v_cvt_pk_bf16_f32 v145, v82, v83
    v_cvt_pk_bf16_f32 v146, v84, v85
    v_cvt_pk_bf16_f32 v147, v86, v87
    v_cvt_pk_bf16_f32 v148, v88, v89
    v_cvt_pk_bf16_f32 v149, v90, v91
    v_cvt_pk_bf16_f32 v150, v92, v93
    v_cvt_pk_bf16_f32 v151, v94, v95
    s_waitcnt vmcnt(0)
    v_cvt_pk_bf16_f32 v152, v96, v97
    v_cvt_pk_bf16_f32 v153, v98, v99
    v_cvt_pk_bf16_f32 v154, v100, v101
    v_cvt_pk_bf16_f32 v155, v102, v103
    v_cvt_pk_bf16_f32 v156, v104, v105
    v_cvt_pk_bf16_f32 v157, v106, v107
    v_cvt_pk_bf16_f32 v158, v108, v109
    v_cvt_pk_bf16_f32 v159, v110, v111
    s_mov_b64 exec, 1
    v_mov_b32 v252, 155680
    v_mov_b32 v253, 1
    ds_add_u32 v252, v253
    s_mov_b64 exec, -1
    s_cmp_lg_u32 s6, 6
    s_cbranch_scc1 os_sk0
    ds_read_b128 v[176:179], v14 offset:0
    ds_read_b128 v[180:183], v14 offset:1024
    ds_read_b128 v[184:187], v14 offset:2048
    ds_read_b128 v[188:191], v14 offset:3072
    s_waitcnt lgkmcnt(0)
    v_mfma_f32_32x32x16_bf16 v[192:207], v[144:147], v[176:179], 0
    v_mfma_f32_32x32x16_bf16 v[192:207], v[148:151], v[180:183], v[192:207]
    v_mfma_f32_32x32x16_bf16 v[208:223], v[152:155], v[184:187], 0
    v_mfma_f32_32x32x16_bf16 v[208:223], v[156:159], v[188:191], v[208:223]
    s_nop 7
    s_nop 1
    v_add_f32 v200, 897988541, v200
    v_rcp_f32 v200, v200
    s_nop 0
    v_mul_f32 v192, v192, v200
    v_mul_f32 v193, v193, v200
    v_mul_f32 v194, v194, v200
    v_mul_f32 v195, v195, v200
    v_mul_f32 v196, v196, v200
    v_mul_f32 v197, v197, v200
    v_mul_f32 v198, v198, v200
    v_mul_f32 v199, v199, v200
    v_cvt_pk_bf16_f32 v224, v192, v193
    v_cvt_pk_bf16_f32 v225, v194, v195
    v_cvt_pk_bf16_f32 v226, v196, v197
    v_cvt_pk_bf16_f32 v227, v198, v199
    s_add_u32 s63, s62, 0
    buffer_store_dwordx4 v[224:227], v14, s[24:27], s63 offen sc1
    v_add_f32 v208, 897988541, v208
    v_rcp_f32 v208, v208
    s_nop 0
    v_mul_f32 v216, v216, v208
    v_mul_f32 v217, v217, v208
    v_mul_f32 v218, v218, v208
    v_mul_f32 v219, v219, v208
    v_mul_f32 v220, v220, v208
    v_mul_f32 v221, v221, v208
    v_mul_f32 v222, v222, v208
    v_mul_f32 v223, v223, v208
    v_cvt_pk_bf16_f32 v228, v216, v217
    v_cvt_pk_bf16_f32 v229, v218, v219
    v_cvt_pk_bf16_f32 v230, v220, v221
    v_cvt_pk_bf16_f32 v231, v222, v223
    s_add_u32 s63, s62, 1024
    buffer_store_dwordx4 v[228:231], v14, s[24:27], s63 offen sc1
os_sk0:
    s_nop 7
    s_nop 7
    s_cmp_lg_u32 s6, 6
    s_cbranch_scc1 os_sk1
    ds_read_b128 v[176:179], v14 offset:4096
    ds_read_b128 v[180:183], v14 offset:5120
    ds_read_b128 v[184:187], v14 offset:6144
    ds_read_b128 v[188:191], v14 offset:7168
    s_waitcnt lgkmcnt(0)
    v_mfma_f32_32x32x16_bf16 v[192:207], v[144:147], v[176:179], 0
    v_mfma_f32_32x32x16_bf16 v[192:207], v[148:151], v[180:183], v[192:207]
    v_mfma_f32_32x32x16_bf16 v[208:223], v[152:155], v[184:187], 0
    v_mfma_f32_32x32x16_bf16 v[208:223], v[156:159], v[188:191], v[208:223]
    s_nop 7
    s_nop 1
    v_add_f32 v200, 897988541, v200
    v_rcp_f32 v200, v200
    s_nop 0
    v_mul_f32 v192, v192, v200
    v_mul_f32 v193, v193, v200
    v_mul_f32 v194, v194, v200
    v_mul_f32 v195, v195, v200
    v_mul_f32 v196, v196, v200
    v_mul_f32 v197, v197, v200
    v_mul_f32 v198, v198, v200
    v_mul_f32 v199, v199, v200
    v_cvt_pk_bf16_f32 v232, v192, v193
    v_cvt_pk_bf16_f32 v233, v194, v195
    v_cvt_pk_bf16_f32 v234, v196, v197
    v_cvt_pk_bf16_f32 v235, v198, v199
    s_add_u32 s63, s62, 32768
    buffer_store_dwordx4 v[232:235], v14, s[24:27], s63 offen sc1
    v_add_f32 v208, 897988541, v208
    v_rcp_f32 v208, v208
    s_nop 0
    v_mul_f32 v216, v216, v208
    v_mul_f32 v217, v217, v208
    v_mul_f32 v218, v218, v208
    v_mul_f32 v219, v219, v208
    v_mul_f32 v220, v220, v208
    v_mul_f32 v221, v221, v208
    v_mul_f32 v222, v222, v208
    v_mul_f32 v223, v223, v208
    v_cvt_pk_bf16_f32 v236, v216, v217
    v_cvt_pk_bf16_f32 v237, v218, v219
    v_cvt_pk_bf16_f32 v238, v220, v221
    v_cvt_pk_bf16_f32 v239, v222, v223
    s_add_u32 s63, s62, 33792
    buffer_store_dwordx4 v[236:239], v14, s[24:27], s63 offen sc1
os_sk1:
    s_nop 7
    s_nop 7
    s_cmp_lg_u32 s6, 6
    s_cbranch_scc1 os_sk2
    ds_read_b128 v[176:179], v14 offset:8192
    ds_read_b128 v[180:183], v14 offset:9216
    ds_read_b128 v[184:187], v14 offset:10240
    ds_read_b128 v[188:191], v14 offset:11264
    s_waitcnt lgkmcnt(0)
    v_mfma_f32_32x32x16_bf16 v[192:207], v[144:147], v[176:179], 0
    v_mfma_f32_32x32x16_bf16 v[192:207], v[148:151], v[180:183], v[192:207]
    v_mfma_f32_32x32x16_bf16 v[208:223], v[152:155], v[184:187], 0
    v_mfma_f32_32x32x16_bf16 v[208:223], v[156:159], v[188:191], v[208:223]
    s_nop 7
    s_nop 1
    v_add_f32 v200, 897988541, v200
    v_rcp_f32 v200, v200
    s_nop 0
    v_mul_f32 v192, v192, v200
    v_mul_f32 v193, v193, v200
    v_mul_f32 v194, v194, v200
    v_mul_f32 v195, v195, v200
    v_mul_f32 v196, v196, v200
    v_mul_f32 v197, v197, v200
    v_mul_f32 v198, v198, v200
    v_mul_f32 v199, v199, v200
    v_cvt_pk_bf16_f32 v224, v192, v193
    v_cvt_pk_bf16_f32 v225, v194, v195
    v_cvt_pk_bf16_f32 v226, v196, v197
    v_cvt_pk_bf16_f32 v227, v198, v199
    s_add_u32 s63, s62, 65536
    buffer_store_dwordx4 v[224:227], v14, s[24:27], s63 offen sc1
    v_add_f32 v208, 897988541, v208
    v_rcp_f32 v208, v208
    s_nop 0
    v_mul_f32 v216, v216, v208
    v_mul_f32 v217, v217, v208
    v_mul_f32 v218, v218, v208
    v_mul_f32 v219, v219, v208
    v_mul_f32 v220, v220, v208
    v_mul_f32 v221, v221, v208
    v_mul_f32 v222, v222, v208
    v_mul_f32 v223, v223, v208
    v_cvt_pk_bf16_f32 v228, v216, v217
    v_cvt_pk_bf16_f32 v229, v218, v219
    v_cvt_pk_bf16_f32 v230, v220, v221
    v_cvt_pk_bf16_f32 v231, v222, v223
    s_add_u32 s63, s62, 66560
    buffer_store_dwordx4 v[228:231], v14, s[24:27], s63 offen sc1
os_sk2:
    s_nop 7
    s_nop 7
    s_cmp_lg_u32 s6, 6
    s_cbranch_scc1 os_sk3
    ds_read_b128 v[176:179], v14 offset:12288
    ds_read_b128 v[180:183], v14 offset:13312
    ds_read_b128 v[184:187], v14 offset:14336
    ds_read_b128 v[188:191], v14 offset:15360
    s_waitcnt lgkmcnt(0)
    v_mfma_f32_32x32x16_bf16 v[192:207], v[144:147], v[176:179], 0
    v_mfma_f32_32x32x16_bf16 v[192:207], v[148:151], v[180:183], v[192:207]
    v_mfma_f32_32x32x16_bf16 v[208:223], v[152:155], v[184:187], 0
    v_mfma_f32_32x32x16_bf16 v[208:223], v[156:159], v[188:191], v[208:223]
    s_nop 7
    s_nop 1
    v_add_f32 v200, 897988541, v200
    v_rcp_f32 v200, v200
    s_nop 0
    v_mul_f32 v192, v192, v200
    v_mul_f32 v193, v193, v200
    v_mul_f32 v194, v194, v200
    v_mul_f32 v195, v195, v200
    v_mul_f32 v196, v196, v200
    v_mul_f32 v197, v197, v200
    v_mul_f32 v198, v198, v200
    v_mul_f32 v199, v199, v200
    v_cvt_pk_bf16_f32 v232, v192, v193
    v_cvt_pk_bf16_f32 v233, v194, v195
    v_cvt_pk_bf16_f32 v234, v196, v197
    v_cvt_pk_bf16_f32 v235, v198, v199
    s_add_u32 s63, s62, 98304
    buffer_store_dwordx4 v[232:235], v14, s[24:27], s63 offen sc1
    v_add_f32 v208, 897988541, v208
    v_rcp_f32 v208, v208
    s_nop 0
    v_mul_f32 v216, v216, v208
    v_mul_f32 v217, v217, v208
    v_mul_f32 v218, v218, v208
    v_mul_f32 v219, v219, v208
    v_mul_f32 v220, v220, v208
    v_mul_f32 v221, v221, v208
    v_mul_f32 v222, v222, v208
    v_mul_f32 v223, v223, v208
    v_cvt_pk_bf16_f32 v236, v216, v217
    v_cvt_pk_bf16_f32 v237, v218, v219
    v_cvt_pk_bf16_f32 v238, v220, v221
    v_cvt_pk_bf16_f32 v239, v222, v223
    s_add_u32 s63, s62, 99328
    buffer_store_dwordx4 v[236:239], v14, s[24:27], s63 offen sc1
os_sk3:
    s_nop 7
    s_nop 7
    s_cmp_lg_u32 s6, 7
    s_cbranch_scc1 os_sk4
    ds_read_b128 v[176:179], v14 offset:16384
    ds_read_b128 v[180:183], v14 offset:17408
    ds_read_b128 v[184:187], v14 offset:18432
    ds_read_b128 v[188:191], v14 offset:19456
    s_waitcnt lgkmcnt(0)
    v_mfma_f32_32x32x16_bf16 v[192:207], v[144:147], v[176:179], 0
    v_mfma_f32_32x32x16_bf16 v[192:207], v[148:151], v[180:183], v[192:207]
    v_mfma_f32_32x32x16_bf16 v[208:223], v[152:155], v[184:187], 0
    v_mfma_f32_32x32x16_bf16 v[208:223], v[156:159], v[188:191], v[208:223]
    s_nop 7
    s_nop 1
    v_add_f32 v200, 897988541, v200
    v_rcp_f32 v200, v200
    s_nop 0
    v_mul_f32 v192, v192, v200
    v_mul_f32 v193, v193, v200
    v_mul_f32 v194, v194, v200
    v_mul_f32 v195, v195, v200
    v_mul_f32 v196, v196, v200
    v_mul_f32 v197, v197, v200
    v_mul_f32 v198, v198, v200
    v_mul_f32 v199, v199, v200
    v_cvt_pk_bf16_f32 v224, v192, v193
    v_cvt_pk_bf16_f32 v225, v194, v195
    v_cvt_pk_bf16_f32 v226, v196, v197
    v_cvt_pk_bf16_f32 v227, v198, v199
    s_add_u32 s63, s62, 2048
    buffer_store_dwordx4 v[224:227], v14, s[24:27], s63 offen sc1
    v_add_f32 v208, 897988541, v208
    v_rcp_f32 v208, v208
    s_nop 0
    v_mul_f32 v216, v216, v208
    v_mul_f32 v217, v217, v208
    v_mul_f32 v218, v218, v208
    v_mul_f32 v219, v219, v208
    v_mul_f32 v220, v220, v208
    v_mul_f32 v221, v221, v208
    v_mul_f32 v222, v222, v208
    v_mul_f32 v223, v223, v208
    v_cvt_pk_bf16_f32 v228, v216, v217
    v_cvt_pk_bf16_f32 v229, v218, v219
    v_cvt_pk_bf16_f32 v230, v220, v221
    v_cvt_pk_bf16_f32 v231, v222, v223
    s_add_u32 s63, s62, 3072
    buffer_store_dwordx4 v[228:231], v14, s[24:27], s63 offen sc1
os_sk4:
    s_nop 7
    s_nop 7
    s_cmp_lg_u32 s6, 7
    s_cbranch_scc1 os_sk5
    ds_read_b128 v[176:179], v14 offset:20480
    ds_read_b128 v[180:183], v14 offset:21504
    ds_read_b128 v[184:187], v14 offset:22528
    ds_read_b128 v[188:191], v14 offset:23552
    s_waitcnt lgkmcnt(0)
    v_mfma_f32_32x32x16_bf16 v[192:207], v[144:147], v[176:179], 0
    v_mfma_f32_32x32x16_bf16 v[192:207], v[148:151], v[180:183], v[192:207]
    v_mfma_f32_32x32x16_bf16 v[208:223], v[152:155], v[184:187], 0
    v_mfma_f32_32x32x16_bf16 v[208:223], v[156:159], v[188:191], v[208:223]
    s_nop 7
    s_nop 1
    v_add_f32 v200, 897988541, v200
    v_rcp_f32 v200, v200
    s_nop 0
    v_mul_f32 v192, v192, v200
    v_mul_f32 v193, v193, v200
    v_mul_f32 v194, v194, v200
    v_mul_f32 v195, v195, v200
    v_mul_f32 v196, v196, v200
    v_mul_f32 v197, v197, v200
    v_mul_f32 v198, v198, v200
    v_mul_f32 v199, v199, v200
    v_cvt_pk_bf16_f32 v232, v192, v193
    v_cvt_pk_bf16_f32 v233, v194, v195
    v_cvt_pk_bf16_f32 v234, v196, v197
    v_cvt_pk_bf16_f32 v235, v198, v199
    s_add_u32 s63, s62, 34816
    buffer_store_dwordx4 v[232:235], v14, s[24:27], s63 offen sc1
    v_add_f32 v208, 897988541, v208
    v_rcp_f32 v208, v208
    s_nop 0
    v_mul_f32 v216, v216, v208
    v_mul_f32 v217, v217, v208
    v_mul_f32 v218, v218, v208
    v_mul_f32 v219, v219, v208
    v_mul_f32 v220, v220, v208
    v_mul_f32 v221, v221, v208
    v_mul_f32 v222, v222, v208
    v_mul_f32 v223, v223, v208
    v_cvt_pk_bf16_f32 v236, v216, v217
    v_cvt_pk_bf16_f32 v237, v218, v219
    v_cvt_pk_bf16_f32 v238, v220, v221
    v_cvt_pk_bf16_f32 v239, v222, v223
    s_add_u32 s63, s62, 35840
    buffer_store_dwordx4 v[236:239], v14, s[24:27], s63 offen sc1
os_sk5:
    s_nop 7
    s_nop 7
    s_cmp_lg_u32 s6, 7
    s_cbranch_scc1 os_sk6
    ds_read_b128 v[176:179], v14 offset:24576
    ds_read_b128 v[180:183], v14 offset:25600
    ds_read_b128 v[184:187], v14 offset:26624
    ds_read_b128 v[188:191], v14 offset:27648
    s_waitcnt lgkmcnt(0)
    v_mfma_f32_32x32x16_bf16 v[192:207], v[144:147], v[176:179], 0
    v_mfma_f32_32x32x16_bf16 v[192:207], v[148:151], v[180:183], v[192:207]
    v_mfma_f32_32x32x16_bf16 v[208:223], v[152:155], v[184:187], 0
    v_mfma_f32_32x32x16_bf16 v[208:223], v[156:159], v[188:191], v[208:223]
    s_nop 7
    s_nop 1
    v_add_f32 v200, 897988541, v200
    v_rcp_f32 v200, v200
    s_nop 0
    v_mul_f32 v192, v192, v200
    v_mul_f32 v193, v193, v200
    v_mul_f32 v194, v194, v200
    v_mul_f32 v195, v195, v200
    v_mul_f32 v196, v196, v200
    v_mul_f32 v197, v197, v200
    v_mul_f32 v198, v198, v200
    v_mul_f32 v199, v199, v200
    v_cvt_pk_bf16_f32 v224, v192, v193
    v_cvt_pk_bf16_f32 v225, v194, v195
    v_cvt_pk_bf16_f32 v226, v196, v197
    v_cvt_pk_bf16_f32 v227, v198, v199
    s_add_u32 s63, s62, 67584
    buffer_store_dwordx4 v[224:227], v14, s[24:27], s63 offen sc1
    v_add_f32 v208, 897988541, v208
    v_rcp_f32 v208, v208
    s_nop 0
    v_mul_f32 v216, v216, v208
    v_mul_f32 v217, v217, v208
    v_mul_f32 v218, v218, v208
    v_mul_f32 v219, v219, v208
    v_mul_f32 v220, v220, v208
    v_mul_f32 v221, v221, v208
    v_mul_f32 v222, v222, v208
    v_mul_f32 v223, v223, v208
    v_cvt_pk_bf16_f32 v228, v216, v217
    v_cvt_pk_bf16_f32 v229, v218, v219
    v_cvt_pk_bf16_f32 v230, v220, v221
    v_cvt_pk_bf16_f32 v231, v222, v223
    s_add_u32 s63, s62, 68608
    buffer_store_dwordx4 v[228:231], v14, s[24:27], s63 offen sc1
os_sk6:
    s_nop 7
    s_nop 7
    s_cmp_lg_u32 s6, 7
    s_cbranch_scc1 os_sk7
    ds_read_b128 v[176:179], v14 offset:28672
    ds_read_b128 v[180:183], v14 offset:29696
    ds_read_b128 v[184:187], v14 offset:30720
    ds_read_b128 v[188:191], v14 offset:31744
    s_waitcnt lgkmcnt(0)
    v_mfma_f32_32x32x16_bf16 v[192:207], v[144:147], v[176:179], 0
    v_mfma_f32_32x32x16_bf16 v[192:207], v[148:151], v[180:183], v[192:207]
    v_mfma_f32_32x32x16_bf16 v[208:223], v[152:155], v[184:187], 0
    v_mfma_f32_32x32x16_bf16 v[208:223], v[156:159], v[188:191], v[208:223]
    s_nop 7
    s_nop 1
    v_add_f32 v200, 897988541, v200
    v_rcp_f32 v200, v200
    s_nop 0
    v_mul_f32 v192, v192, v200
    v_mul_f32 v193, v193, v200
    v_mul_f32 v194, v194, v200
    v_mul_f32 v195, v195, v200
    v_mul_f32 v196, v196, v200
    v_mul_f32 v197, v197, v200
    v_mul_f32 v198, v198, v200
    v_mul_f32 v199, v199, v200
    v_cvt_pk_bf16_f32 v232, v192, v193
    v_cvt_pk_bf16_f32 v233, v194, v195
    v_cvt_pk_bf16_f32 v234, v196, v197
    v_cvt_pk_bf16_f32 v235, v198, v199
    s_add_u32 s63, s62, 100352
    buffer_store_dwordx4 v[232:235], v14, s[24:27], s63 offen sc1
    v_add_f32 v208, 897988541, v208
    v_rcp_f32 v208, v208
    s_nop 0
    v_mul_f32 v216, v216, v208
    v_mul_f32 v217, v217, v208
    v_mul_f32 v218, v218, v208
    v_mul_f32 v219, v219, v208
    v_mul_f32 v220, v220, v208
    v_mul_f32 v221, v221, v208
    v_mul_f32 v222, v222, v208
    v_mul_f32 v223, v223, v208
    v_cvt_pk_bf16_f32 v236, v216, v217
    v_cvt_pk_bf16_f32 v237, v218, v219
    v_cvt_pk_bf16_f32 v238, v220, v221
    v_cvt_pk_bf16_f32 v239, v222, v223
    s_add_u32 s63, s62, 101376
    buffer_store_dwordx4 v[236:239], v14, s[24:27], s63 offen sc1
os_sk7:
    s_nop 7
    s_nop 7
    s_waitcnt vmcnt(0)
    s_mov_b64 exec, 1
    v_mov_b32 v252, 155668
    v_mov_b32 v253, 1
    ds_add_rtn_u32 v254, v252, v253
    s_waitcnt lgkmcnt(0)
    v_readfirstlane_b32 s3, v254
    s_nop 0
    s_cmp_lg_u32 s3, 1
    s_cbranch_scc1 sg_o
    s_mov_b64 exec, 3
    s_mul_i32 s3, s4, 512
    s_add_u32 s3, s3, 12
    v_mul_u32_u24 v252, 256, v1
    v_mov_b32 v253, 1
    buffer_atomic_add v253, v252, s[16:19], s3 offen
sg_o:
    s_mov_b64 exec, -1
os_end:
    s_endpgm
k1_mlp:
    s_mov_b32 s8, s32
    s_mov_b32 s9, s33
    s_mov_b32 s10, 2097152
    s_mov_b32 s11, 0x00020000
    s_mov_b32 s12, s42
    s_mov_b32 s13, s43
    s_mov_b32 s14, 1409024
    s_mov_b32 s15, 0x00020000
    s_mov_b32 s16, s44
    s_mov_b32 s17, s45
    s_mov_b32 s18, 2752
    s_mov_b32 s19, 0x00020000
    s_mov_b32 s24, s56
    s_mov_b32 s25, s57
    s_mov_b32 s26, 5636096
    s_mov_b32 s27, 0x00020000
    v_and_b32 v7, 31, v1
    v_lshrrev_b32 v15, 5, v1
    s_mov_b32 s20, s50
    s_mov_b32 s21, s51
    s_mov_b32 s22, 1024
    s_mov_b32 s23, 0x00020000
    v_lshlrev_b32 v133, 4, v1
    s_cmp_lg_u32 s6, 0
    s_cbranch_scc1 k1m_nogate
    s_mul_i32 s3, s5, 128
    v_add_u32 v134, s3, v133
    v_and_b32 v134, 1023, v134
    s_mov_b32 m0, 122880
    s_nop 0
    buffer_load_dwordx4 v134, s[20:23], 0 offen lds
k1m_nogate:
    s_nop 1
    s_mul_i32 s3, s5, 6
    s_add_u32 s3, s3, s58
    s_lshl_b32 s3, s3, 6
    v_lshlrev_b32 v132, 3, v15
    v_add_u32 v132, s3, v132
    buffer_load_dwordx2 v[184:185], v132, s[16:19], 0 offen offset:0
    buffer_load_dwordx2 v[186:187], v132, s[16:19], 0 offen offset:16
    buffer_load_dwordx2 v[188:189], v132, s[16:19], 0 offen offset:32
    buffer_load_dwordx2 v[190:191], v132, s[16:19], 0 offen offset:48
    buffer_load_dwordx2 v[192:193], v132, s[16:19], 0 offen offset:128
    buffer_load_dwordx2 v[194:195], v132, s[16:19], 0 offen offset:144
    buffer_load_dwordx2 v[196:197], v132, s[16:19], 0 offen offset:160
    buffer_load_dwordx2 v[198:199], v132, s[16:19], 0 offen offset:176
    buffer_load_dwordx2 v[200:201], v132, s[16:19], 0 offen offset:256
    buffer_load_dwordx2 v[202:203], v132, s[16:19], 0 offen offset:272
    buffer_load_dwordx2 v[204:205], v132, s[16:19], 0 offen offset:288
    buffer_load_dwordx2 v[206:207], v132, s[16:19], 0 offen offset:304
    v_lshrrev_b32 v132, 3, v1
    s_lshl_b32 s3, s4, 7
    s_lshl_b32 s59, s6, 4
    s_add_u32 s3, s3, s59
    v_add_u32 v132, s3, v132
    v_lshlrev_b32 v132, 10, v132
    v_and_b32 v133, 7, v1
    v_lshrrev_b32 v134, 4, v1
    v_xor_b32 v135, v133, v134
    v_lshl_add_u32 v2, v135, 4, v132
    v_xor_b32 v135, 4, v135
    v_lshl_add_u32 v3, v135, 4, v132
    v_add_u32 v3, 8192, v3
    v_bfe_u32 v132, v1, 2, 2
    s_lshl_b32 s3, s6, 3
    v_add_u32 v132, s3, v132
    s_mov_b32 s59, 2752
    v_mul_lo_u32 v132, v132, s59
    v_and_b32 v133, 3, v1
    v_lshl_add_u32 v132, v133, 4, v132
    s_mul_i32 s3, s5, 384
    v_add_u32 v132, s3, v132
    v_lshrrev_b32 v134, 4, v1
    v_lshrrev_b32 v136, 1, v134
    v_mul_u32_u24 v136, 128, v136
    v_and_b32 v137, 1, v134
    v_lshl_add_u32 v136, v137, 6, v136
    v_add_u32 v4, v132, v136
    v_add_u32 v135, 4, v134
    v_subrev_u32 v138, 2, v134
    v_cmp_gt_u32 vcc, 32, v1
    s_nop 1
    v_cndmask_b32 v135, v138, v135, vcc
    v_lshrrev_b32 v136, 1, v135
    v_mul_u32_u24 v136, 128, v136
    v_and_b32 v137, 1, v135
    v_lshl_add_u32 v136, v137, 6, v136
    v_add_u32 v5, v132, v136
    v_mov_b32 v138, 11008
    v_cndmask_b32 v138, v138, 0, vcc
    v_add_u32 v5, v5, v138
    v_add_u32 v135, 2, v134
    v_lshrrev_b32 v136, 1, v135
    v_mul_u32_u24 v136, 128, v136
    v_and_b32 v137, 1, v135
    v_lshl_add_u32 v136, v137, 6, v136
    v_add_u32 v6, v132, v136
    v_add_u32 v6, 11008, v6
    s_lshl_b32 s60, s6, 11
    s_add_u32 s60, s60, 73728
    s_mul_i32 s61, s6, 3072
    s_mul_i32 s62, s5, 1
    s_add_u32 s62, s62, 0
    s_and_b32 s62, s62, 7
    s_mul_i32 s63, s62, 176128
    s_lshl_b32 s62, s62, 7
    s_add_u32 m0, s60, 0
    s_nop 0
    buffer_load_dwordx4 v2, s[8:11], s62 offen lds
    s_add_u32 m0, s60, 1024
    s_nop 0
    buffer_load_dwordx4 v3, s[8:11], s62 offen lds
    s_add_u32 m0, s61, 0
    s_nop 0
    buffer_load_dwordx4 v4, s[12:15], s63 offen lds
    s_add_u32 m0, s61, 1024
    s_nop 0
    buffer_load_dwordx4 v5, s[12:15], s63 offen lds
    s_add_u32 m0, s61, 2048
    s_nop 0
    buffer_load_dwordx4 v6, s[12:15], s63 offen lds
    s_mul_i32 s62, s5, 1
    s_add_u32 s62, s62, 1
    s_and_b32 s62, s62, 7
    s_mul_i32 s63, s62, 176128
    s_lshl_b32 s62, s62, 7
    s_add_u32 m0, s60, 16384
    s_nop 0
    buffer_load_dwordx4 v2, s[8:11], s62 offen lds
    s_add_u32 m0, s60, 17408
    s_nop 0
    buffer_load_dwordx4 v3, s[8:11], s62 offen lds
    s_add_u32 m0, s61, 24576
    s_nop 0
    buffer_load_dwordx4 v4, s[12:15], s63 offen lds
    s_add_u32 m0, s61, 25600
    s_nop 0
    buffer_load_dwordx4 v5, s[12:15], s63 offen lds
    s_add_u32 m0, s61, 26624
    s_nop 0
    buffer_load_dwordx4 v6, s[12:15], s63 offen lds
    s_lshl_b32 s3, s7, 5
    v_add_u32 v132, s3, v7
    v_lshlrev_b32 v132, 7, v132
    v_add_u32 v132, 73728, v132
    v_bfe_u32 v133, v7, 1, 3
    v_xor_b32 v133, v133, v15
    v_xor_b32 v134, 0, v133
    v_lshl_add_u32 v8, v134, 4, v132
    v_xor_b32 v134, 2, v133
    v_lshl_add_u32 v9, v134, 4, v132
    v_xor_b32 v134, 4, v133
    v_lshl_add_u32 v10, v134, 4, v132
    v_xor_b32 v134, 6, v133
    v_lshl_add_u32 v11, v134, 4, v132
    v_mul_u32_u24 v12, 3072, v15
    v_bfe_u32 v132, v1, 2, 2
    v_lshl_add_u32 v12, v132, 6, v12
    v_bfe_u32 v132, v1, 4, 1
    v_lshl_add_u32 v12, v132, 5, v12
    v_and_b32 v132, 3, v1
    v_lshl_add_u32 v12, v132, 3, v12
    s_lshl_b32 s3, s58, 8
    v_add_u32 v12, s3, v12
    v_add_u32 v13, 49152, v12
    v_mov_b32 v133, 122880
    v_lshl_add_u32 v110, v15, 4, v133
    s_lshl_b32 s3, s58, 6
    v_add_u32 v107, s3, v110
    v_mov_b32 v108, 1065369472
    v_mov_b32 v109, 1065369472
    v_and_b32 v132, 31, v1
    v_cmp_eq_u32 vcc, 0, v132
    v_mov_b32 v133, 1065369472
    s_nop 0
    v_cndmask_b32 v220, 0, v133, vcc
    v_cmp_eq_u32 vcc, 17, v132
    s_nop 1
    v_cndmask_b32 v220, v220, v133, vcc
    v_mov_b32 v221, v220
    v_mov_b32 v222, v220
    v_mov_b32 v223, v220
    v_mov_b32 v96, 0
    v_mov_b32 v97, 0
    v_mov_b32 v98, 0
    v_mov_b32 v99, 0
    v_mov_b32 v100, 0
    v_mov_b32 v101, 0
    v_mov_b32 v102, 0
    v_mov_b32 v103, 0
    v_mov_b32 v120, 0
    v_mov_b32 v121, 0
    v_mov_b32 v122, 0
    v_mov_b32 v123, 0
    v_mov_b32 v124, 0
    v_mov_b32 v125, 0
    v_mov_b32 v126, 0
    v_mov_b32 v127, 0
    v_mov_b32 v224, 0
    v_mov_b32 v225, 0
    v_mov_b32 v226, 0
    v_mov_b32 v227, 0
    v_mov_b32 v228, 0
    v_mov_b32 v229, 0
    v_mov_b32 v230, 0
    v_mov_b32 v231, 0
    v_mov_b32 v208, 0
    v_mov_b32 v209, 0
    v_mov_b32 v210, 0
    v_mov_b32 v211, 0
    v_mov_b32 v212, 0
    v_mov_b32 v213, 0
    v_mov_b32 v214, 0
    v_mov_b32 v215, 0
    v_mov_b32 v216, 0
    v_mov_b32 v217, 0
    v_mov_b32 v218, 0
    v_mov_b32 v219, 0
    s_mov_b32 s64, 1065369472
    s_mov_b32 s68, s46
    s_mov_b32 s69, s47
    s_mov_b32 s70, 1409024
    s_mov_b32 s71, 0x00020000
    s_mov_b32 s76, s38
    s_mov_b32 s77, s39
    s_mov_b32 s78, 524288
    s_mov_b32 s79, 0x00020000
    s_lshr_b32 s67, s2, 3
    s_lshl_b32 s67, s67, 3
    s_add_u32 s67, s67, s6
    s_lshl_b32 s67, s67, 10
    v_lshlrev_b32 v111, 4, v1
    s_lshl_b32 s66, s6, 10
    s_add_u32 s66, s66, 131072
    s_mov_b32 s72, s54
    s_mov_b32 s73, s55
    s_mov_b32 s74, 256
    s_mov_b32 s75, 0x00020000
    v_mov_b32 v251, 0
    v_mov_b32 v249, 0
    s_waitcnt vmcnt(5)
    s_barrier
    s_cmp_lg_u32 s5, 7
    s_cbranch_scc1 k1m_ng0
    ds_read_b128 v[112:115], v107 offset:0
    ds_read_b128 v[116:119], v107 offset:32
k1m_ng0:
    ds_read_b128 v[64:67], v8 offset:0
    ds_read_b64_tr_b16 v[68:69], v12 offset:0
    ds_read_b64_tr_b16 v[70:71], v12 offset:1536
    ds_read_b64_tr_b16 v[72:73], v12 offset:512
    ds_read_b64_tr_b16 v[74:75], v12 offset:2048
    ds_read_b64_tr_b16 v[76:77], v12 offset:1024
    ds_read_b64_tr_b16 v[78:79], v12 offset:2560
    s_mul_i32 s62, s5, 1
    s_add_u32 s62, s62, 2
    s_and_b32 s62, s62, 7
    s_mul_i32 s63, s62, 176128
    s_lshl_b32 s62, s62, 7
    ds_read_b128 v[80:83], v9 offset:0
    ds_read_b64_tr_b16 v[84:85], v12 offset:6144
    ds_read_b64_tr_b16 v[86:87], v12 offset:7680
    ds_read_b64_tr_b16 v[88:89], v12 offset:6656
    ds_read_b64_tr_b16 v[90:91], v12 offset:8192
    ds_read_b64_tr_b16 v[92:93], v12 offset:7168
    ds_read_b64_tr_b16 v[94:95], v12 offset:8704
    s_waitcnt lgkmcnt(7)
    v_mfma_f32_32x32x16_bf16 v[16:31], v[68:71], v[64:67], 0
    s_add_u32 m0, s60, 32768
    s_nop 0
    buffer_load_dwordx4 v2, s[8:11], s62 offen lds
    v_mfma_f32_32x32x16_bf16 v[32:47], v[72:75], v[64:67], 0
    v_mfma_f32_32x32x16_bf16 v[48:63], v[76:79], v[64:67], 0
    s_cmp_lg_u32 s58, 0
    s_cbranch_scc1 k1m_st0_0
    v_mfma_f32_4x4x4_16b_bf16 v[120:123], v[64:65], v[64:65], v[120:123]
    v_mfma_f32_4x4x4_16b_bf16 v[124:127], v[108:109], v[64:65], v[124:127]
    v_mfma_f32_4x4x4_16b_bf16 v[96:99], v[66:67], v[66:67], v[96:99]
    v_mfma_f32_4x4x4_16b_bf16 v[100:103], v[108:109], v[66:67], v[100:103]
    s_cmp_lg_u32 s5, 7
    s_cbranch_scc1 k1m_st0_0
    v_mfma_f32_4x4x4_16b_bf16 v[224:227], v[112:113], v[64:65], v[224:227]
    v_mfma_f32_4x4x4_16b_bf16 v[228:231], v[114:115], v[66:67], v[228:231]
k1m_st0_0:
    s_cmp_lg_u32 s7, 0
    s_cbranch_scc1 k1m_cs0_0
    v_mfma_f32_16x16x32_bf16 v[208:211], v[220:223], v[68:71], v[208:211]
    v_mfma_f32_16x16x32_bf16 v[212:215], v[220:223], v[72:75], v[212:215]
    v_mfma_f32_16x16x32_bf16 v[216:219], v[220:223], v[76:79], v[216:219]
k1m_cs0_0:
    ds_read_b128 v[64:67], v10 offset:0
    ds_read_b64_tr_b16 v[68:69], v12 offset:12288
    ds_read_b64_tr_b16 v[70:71], v12 offset:13824
    ds_read_b64_tr_b16 v[72:73], v12 offset:12800
    ds_read_b64_tr_b16 v[74:75], v12 offset:14336
    ds_read_b64_tr_b16 v[76:77], v12 offset:13312
    ds_read_b64_tr_b16 v[78:79], v12 offset:14848
    s_waitcnt lgkmcnt(7)
    v_mfma_f32_32x32x16_bf16 v[16:31], v[84:87], v[80:83], v[16:31]
    s_add_u32 m0, s60, 33792
    s_nop 0
    buffer_load_dwordx4 v3, s[8:11], s62 offen lds
    v_mfma_f32_32x32x16_bf16 v[32:47], v[88:91], v[80:83], v[32:47]
    v_mfma_f32_32x32x16_bf16 v[48:63], v[92:95], v[80:83], v[48:63]
    s_cmp_lg_u32 s58, 0
    s_cbranch_scc1 k1m_st0_1
    v_mfma_f32_4x4x4_16b_bf16 v[120:123], v[80:81], v[80:81], v[120:123]
    v_mfma_f32_4x4x4_16b_bf16 v[124:127], v[108:109], v[80:81], v[124:127]
    v_mfma_f32_4x4x4_16b_bf16 v[96:99], v[82:83], v[82:83], v[96:99]
    v_mfma_f32_4x4x4_16b_bf16 v[100:103], v[108:109], v[82:83], v[100:103]
    s_cmp_lg_u32 s5, 7
    s_cbranch_scc1 k1m_st0_1
    v_mfma_f32_4x4x4_16b_bf16 v[224:227], v[116:117], v[80:81], v[224:227]
    v_mfma_f32_4x4x4_16b_bf16 v[228:231], v[118:119], v[82:83], v[228:231]
k1m_st0_1:
    s_cmp_lg_u32 s7, 1
    s_cbranch_scc1 k1m_cs0_1
    v_mfma_f32_16x16x32_bf16 v[208:211], v[220:223], v[84:87], v[208:211]
    v_mfma_f32_16x16x32_bf16 v[212:215], v[220:223], v[88:91], v[212:215]
    v_mfma_f32_16x16x32_bf16 v[216:219], v[220:223], v[92:95], v[216:219]
k1m_cs0_1:
    ds_read_b128 v[80:83], v11 offset:0
    ds_read_b64_tr_b16 v[84:85], v12 offset:18432
    ds_read_b64_tr_b16 v[86:87], v12 offset:19968
    ds_read_b64_tr_b16 v[88:89], v12 offset:18944
    ds_read_b64_tr_b16 v[90:91], v12 offset:20480
    ds_read_b64_tr_b16 v[92:93], v12 offset:19456
    ds_read_b64_tr_b16 v[94:95], v12 offset:20992
    s_waitcnt lgkmcnt(7)
    v_mfma_f32_32x32x16_bf16 v[16:31], v[68:71], v[64:67], v[16:31]
    s_add_u32 m0, s61, 49152
    s_nop 0
    buffer_load_dwordx4 v4, s[12:15], s63 offen lds
    v_mfma_f32_32x32x16_bf16 v[32:47], v[72:75], v[64:67], v[32:47]
    v_mfma_f32_32x32x16_bf16 v[48:63], v[76:79], v[64:67], v[48:63]
    s_cmp_lg_u32 s58, 1
    s_cbranch_scc1 k1m_st0_2
    v_mfma_f32_4x4x4_16b_bf16 v[120:123], v[64:65], v[64:65], v[120:123]
    v_mfma_f32_4x4x4_16b_bf16 v[124:127], v[108:109], v[64:65], v[124:127]
    v_mfma_f32_4x4x4_16b_bf16 v[96:99], v[66:67], v[66:67], v[96:99]
    v_mfma_f32_4x4x4_16b_bf16 v[100:103], v[108:109], v[66:67], v[100:103]
    s_cmp_lg_u32 s5, 7
    s_cbranch_scc1 k1m_st0_2
    v_mfma_f32_4x4x4_16b_bf16 v[224:227], v[112:113], v[64:65], v[224:227]
    v_mfma_f32_4x4x4_16b_bf16 v[228:231], v[114:115], v[66:67], v[228:231]
k1m_st0_2:
    s_cmp_lg_u32 s7, 2
    s_cbranch_scc1 k1m_cs0_2
    v_mfma_f32_16x16x32_bf16 v[208:211], v[220:223], v[68:71], v[208:211]
    v_mfma_f32_16x16x32_bf16 v[212:215], v[220:223], v[72:75], v[212:215]
    v_mfma_f32_16x16x32_bf16 v[216:219], v[220:223], v[76:79], v[216:219]
k1m_cs0_2:
    s_waitcnt lgkmcnt(0)
    v_mfma_f32_32x32x16_bf16 v[16:31], v[84:87], v[80:83], v[16:31]
    s_add_u32 m0, s61, 50176
    s_nop 0
    buffer_load_dwordx4 v5, s[12:15], s63 offen lds
    v_mfma_f32_32x32x16_bf16 v[32:47], v[88:91], v[80:83], v[32:47]
    v_mfma_f32_32x32x16_bf16 v[48:63], v[92:95], v[80:83], v[48:63]
    s_cmp_lg_u32 s58, 1
    s_cbranch_scc1 k1m_st0_3
    v_mfma_f32_4x4x4_16b_bf16 v[120:123], v[80:81], v[80:81], v[120:123]
    v_mfma_f32_4x4x4_16b_bf16 v[124:127], v[108:109], v[80:81], v[124:127]
    v_mfma_f32_4x4x4_16b_bf16 v[96:99], v[82:83], v[82:83], v[96:99]
    v_mfma_f32_4x4x4_16b_bf16 v[100:103], v[108:109], v[82:83], v[100:103]
    s_cmp_lg_u32 s5, 7
    s_cbranch_scc1 k1m_st0_3
    v_mfma_f32_4x4x4_16b_bf16 v[224:227], v[116:117], v[80:81], v[224:227]
    v_mfma_f32_4x4x4_16b_bf16 v[228:231], v[118:119], v[82:83], v[228:231]
k1m_st0_3:
    s_cmp_lg_u32 s7, 3
    s_cbranch_scc1 k1m_cs0_3
    v_mfma_f32_16x16x32_bf16 v[208:211], v[220:223], v[84:87], v[208:211]
    v_mfma_f32_16x16x32_bf16 v[212:215], v[220:223], v[88:91], v[212:215]
    v_mfma_f32_16x16x32_bf16 v[216:219], v[220:223], v[92:95], v[216:219]
k1m_cs0_3:
    s_add_u32 m0, s61, 51200
    s_nop 0
    buffer_load_dwordx4 v6, s[12:15], s63 offen lds
    s_add_u32 s3, s67, 0
    s_mov_b32 m0, s66
    s_nop 0
    buffer_load_dwordx4 v111, s[68:71], s3 offen lds
    s_add_u32 s3, s67, 262144
    s_mov_b32 m0, s66
    s_nop 0
    buffer_load_dwordx4 v111, s[68:71], s3 offen lds
    s_waitcnt vmcnt(7)
    s_barrier
    s_cmp_lg_u32 s5, 7
    s_cbranch_scc1 k1m_ng1
    ds_read_b128 v[112:115], v107 offset:128
    ds_read_b128 v[116:119], v107 offset:160
k1m_ng1:
    ds_read_b128 v[64:67], v8 offset:16384
    ds_read_b64_tr_b16 v[68:69], v12 offset:24576
    ds_read_b64_tr_b16 v[70:71], v12 offset:26112
    ds_read_b64_tr_b16 v[72:73], v12 offset:25088
    ds_read_b64_tr_b16 v[74:75], v12 offset:26624
    ds_read_b64_tr_b16 v[76:77], v12 offset:25600
    ds_read_b64_tr_b16 v[78:79], v12 offset:27136
    s_mul_i32 s62, s5, 1
    s_add_u32 s62, s62, 3
    s_and_b32 s62, s62, 7
    s_mul_i32 s63, s62, 176128
    s_lshl_b32 s62, s62, 7
    ds_read_b128 v[80:83], v9 offset:16384
    ds_read_b64_tr_b16 v[84:85], v12 offset:30720
    ds_read_b64_tr_b16 v[86:87], v12 offset:32256
    ds_read_b64_tr_b16 v[88:89], v12 offset:31232
    ds_read_b64_tr_b16 v[90:91], v12 offset:32768
    ds_read_b64_tr_b16 v[92:93], v12 offset:31744
    ds_read_b64_tr_b16 v[94:95], v12 offset:33280
    s_waitcnt lgkmcnt(7)
    v_mfma_f32_32x32x16_bf16 v[16:31], v[68:71], v[64:67], v[16:31]
    s_add_u32 m0, s60, 0
    s_nop 0
    buffer_load_dwordx4 v2, s[8:11], s62 offen lds
    v_mfma_f32_32x32x16_bf16 v[32:47], v[72:75], v[64:67], v[32:47]
    v_mfma_f32_32x32x16_bf16 v[48:63], v[76:79], v[64:67], v[48:63]
    s_cmp_lg_u32 s58, 0
    s_cbranch_scc1 k1m_st1_0
    v_mfma_f32_4x4x4_16b_bf16 v[120:123], v[64:65], v[64:65], v[120:123]
    v_mfma_f32_4x4x4_16b_bf16 v[124:127], v[108:109], v[64:65], v[124:127]
    v_mfma_f32_4x4x4_16b_bf16 v[96:99], v[66:67], v[66:67], v[96:99]
    v_mfma_f32_4x4x4_16b_bf16 v[100:103], v[108:109], v[66:67], v[100:103]
    s_cmp_lg_u32 s5, 7
    s_cbranch_scc1 k1m_st1_0
    v_mfma_f32_4x4x4_16b_bf16 v[224:227], v[112:113], v[64:65], v[224:227]
    v_mfma_f32_4x4x4_16b_bf16 v[228:231], v[114:115], v[66:67], v[228:231]
k1m_st1_0:
    s_cmp_lg_u32 s7, 0
    s_cbranch_scc1 k1m_cs1_0
    v_mfma_f32_16x16x32_bf16 v[208:211], v[220:223], v[68:71], v[208:211]
    v_mfma_f32_16x16x32_bf16 v[212:215], v[220:223], v[72:75], v[212:215]
    v_mfma_f32_16x16x32_bf16 v[216:219], v[220:223], v[76:79], v[216:219]
k1m_cs1_0:
    ds_read_b128 v[64:67], v10 offset:16384
    ds_read_b64_tr_b16 v[68:69], v12 offset:36864
    ds_read_b64_tr_b16 v[70:71], v12 offset:38400
    ds_read_b64_tr_b16 v[72:73], v12 offset:37376
    ds_read_b64_tr_b16 v[74:75], v12 offset:38912
    ds_read_b64_tr_b16 v[76:77], v12 offset:37888
    ds_read_b64_tr_b16 v[78:79], v12 offset:39424
    s_waitcnt lgkmcnt(7)
    v_mfma_f32_32x32x16_bf16 v[16:31], v[84:87], v[80:83], v[16:31]
    s_add_u32 m0, s60, 1024
    s_nop 0
    buffer_load_dwordx4 v3, s[8:11], s62 offen lds
    v_mfma_f32_32x32x16_bf16 v[32:47], v[88:91], v[80:83], v[32:47]
    v_mfma_f32_32x32x16_bf16 v[48:63], v[92:95], v[80:83], v[48:63]
    s_cmp_lg_u32 s58, 0
    s_cbranch_scc1 k1m_st1_1
    v_mfma_f32_4x4x4_16b_bf16 v[120:123], v[80:81], v[80:81], v[120:123]
    v_mfma_f32_4x4x4_16b_bf16 v[124:127], v[108:109], v[80:81], v[124:127]
    v_mfma_f32_4x4x4_16b_bf16 v[96:99], v[82:83], v[82:83], v[96:99]
    v_mfma_f32_4x4x4_16b_bf16 v[100:103], v[108:109], v[82:83], v[100:103]
    s_cmp_lg_u32 s5, 7
    s_cbranch_scc1 k1m_st1_1
    v_mfma_f32_4x4x4_16b_bf16 v[224:227], v[116:117], v[80:81], v[224:227]
    v_mfma_f32_4x4x4_16b_bf16 v[228:231], v[118:119], v[82:83], v[228:231]
k1m_st1_1:
    s_cmp_lg_u32 s7, 1
    s_cbranch_scc1 k1m_cs1_1
    v_mfma_f32_16x16x32_bf16 v[208:211], v[220:223], v[84:87], v[208:211]
    v_mfma_f32_16x16x32_bf16 v[212:215], v[220:223], v[88:91], v[212:215]
    v_mfma_f32_16x16x32_bf16 v[216:219], v[220:223], v[92:95], v[216:219]
k1m_cs1_1:
    ds_read_b128 v[80:83], v11 offset:16384
    ds_read_b64_tr_b16 v[84:85], v12 offset:43008
    ds_read_b64_tr_b16 v[86:87], v12 offset:44544
    ds_read_b64_tr_b16 v[88:89], v12 offset:43520
    ds_read_b64_tr_b16 v[90:91], v12 offset:45056
    ds_read_b64_tr_b16 v[92:93], v12 offset:44032
    ds_read_b64_tr_b16 v[94:95], v12 offset:45568
    s_waitcnt lgkmcnt(7)
    v_mfma_f32_32x32x16_bf16 v[16:31], v[68:71], v[64:67], v[16:31]
    s_add_u32 m0, s61, 0
    s_nop 0
    buffer_load_dwordx4 v4, s[12:15], s63 offen lds
    v_mfma_f32_32x32x16_bf16 v[32:47], v[72:75], v[64:67], v[32:47]
    v_mfma_f32_32x32x16_bf16 v[48:63], v[76:79], v[64:67], v[48:63]
    s_cmp_lg_u32 s58, 1
    s_cbranch_scc1 k1m_st1_2
    v_mfma_f32_4x4x4_16b_bf16 v[120:123], v[64:65], v[64:65], v[120:123]
    v_mfma_f32_4x4x4_16b_bf16 v[124:127], v[108:109], v[64:65], v[124:127]
    v_mfma_f32_4x4x4_16b_bf16 v[96:99], v[66:67], v[66:67], v[96:99]
    v_mfma_f32_4x4x4_16b_bf16 v[100:103], v[108:109], v[66:67], v[100:103]
    s_cmp_lg_u32 s5, 7
    s_cbranch_scc1 k1m_st1_2
    v_mfma_f32_4x4x4_16b_bf16 v[224:227], v[112:113], v[64:65], v[224:227]
    v_mfma_f32_4x4x4_16b_bf16 v[228:231], v[114:115], v[66:67], v[228:231]
k1m_st1_2:
    s_cmp_lg_u32 s7, 2
    s_cbranch_scc1 k1m_cs1_2
    v_mfma_f32_16x16x32_bf16 v[208:211], v[220:223], v[68:71], v[208:211]
    v_mfma_f32_16x16x32_bf16 v[212:215], v[220:223], v[72:75], v[212:215]
    v_mfma_f32_16x16x32_bf16 v[216:219], v[220:223], v[76:79], v[216:219]
k1m_cs1_2:
    s_waitcnt lgkmcnt(0)
    v_mfma_f32_32x32x16_bf16 v[16:31], v[84:87], v[80:83], v[16:31]
    s_add_u32 m0, s61, 1024
    s_nop 0
    buffer_load_dwordx4 v5, s[12:15], s63 offen lds
    v_mfma_f32_32x32x16_bf16 v[32:47], v[88:91], v[80:83], v[32:47]
    v_mfma_f32_32x32x16_bf16 v[48:63], v[92:95], v[80:83], v[48:63]
    s_cmp_lg_u32 s58, 1
    s_cbranch_scc1 k1m_st1_3
    v_mfma_f32_4x4x4_16b_bf16 v[120:123], v[80:81], v[80:81], v[120:123]
    v_mfma_f32_4x4x4_16b_bf16 v[124:127], v[108:109], v[80:81], v[124:127]
    v_mfma_f32_4x4x4_16b_bf16 v[96:99], v[82:83], v[82:83], v[96:99]
    v_mfma_f32_4x4x4_16b_bf16 v[100:103], v[108:109], v[82:83], v[100:103]
    s_cmp_lg_u32 s5, 7
    s_cbranch_scc1 k1m_st1_3
    v_mfma_f32_4x4x4_16b_bf16 v[224:227], v[116:117], v[80:81], v[224:227]
    v_mfma_f32_4x4x4_16b_bf16 v[228:231], v[118:119], v[82:83], v[228:231]
k1m_st1_3:
    s_cmp_lg_u32 s7, 3
    s_cbranch_scc1 k1m_cs1_3
    v_mfma_f32_16x16x32_bf16 v[208:211], v[220:223], v[84:87], v[208:211]
    v_mfma_f32_16x16x32_bf16 v[212:215], v[220:223], v[88:91], v[212:215]
    v_mfma_f32_16x16x32_bf16 v[216:219], v[220:223], v[92:95], v[216:219]
k1m_cs1_3:
    s_add_u32 m0, s61, 2048
    s_nop 0
    buffer_load_dwordx4 v6, s[12:15], s63 offen lds
    s_add_u32 s3, s67, 524288
    s_mov_b32 m0, s66
    s_nop 0
    buffer_load_dwordx4 v111, s[68:71], s3 offen lds
    s_add_u32 s3, s67, 786432
    s_mov_b32 m0, s66
    s_nop 0
    buffer_load_dwordx4 v111, s[68:71], s3 offen lds
    s_waitcnt vmcnt(7)
    s_barrier
    s_cmp_lg_u32 s5, 7
    s_cbranch_scc1 k1m_ng2
    ds_read_b128 v[112:115], v107 offset:256
    ds_read_b128 v[116:119], v107 offset:288
k1m_ng2:
    ds_read_b128 v[64:67], v8 offset:32768
    ds_read_b64_tr_b16 v[68:69], v13 offset:0
    ds_read_b64_tr_b16 v[70:71], v13 offset:1536
    ds_read_b64_tr_b16 v[72:73], v13 offset:512
    ds_read_b64_tr_b16 v[74:75], v13 offset:2048
    ds_read_b64_tr_b16 v[76:77], v13 offset:1024
    ds_read_b64_tr_b16 v[78:79], v13 offset:2560
    s_mul_i32 s62, s5, 1
    s_add_u32 s62, s62, 4
    s_and_b32 s62, s62, 7
    s_mul_i32 s63, s62, 176128
    s_lshl_b32 s62, s62, 7
    ds_read_b128 v[80:83], v9 offset:32768
    ds_read_b64_tr_b16 v[84:85], v13 offset:6144
    ds_read_b64_tr_b16 v[86:87], v13 offset:7680
    ds_read_b64_tr_b16 v[88:89], v13 offset:6656
    ds_read_b64_tr_b16 v[90:91], v13 offset:8192
    ds_read_b64_tr_b16 v[92:93], v13 offset:7168
    ds_read_b64_tr_b16 v[94:95], v13 offset:8704
    s_waitcnt lgkmcnt(7)
    v_mfma_f32_32x32x16_bf16 v[16:31], v[68:71], v[64:67], v[16:31]
    s_add_u32 m0, s60, 16384
    s_nop 0
    buffer_load_dwordx4 v2, s[8:11], s62 offen lds
    v_mfma_f32_32x32x16_bf16 v[32:47], v[72:75], v[64:67], v[32:47]
    v_mfma_f32_32x32x16_bf16 v[48:63], v[76:79], v[64:67], v[48:63]
    s_cmp_lg_u32 s58, 0
    s_cbranch_scc1 k1m_st2_0
    v_mfma_f32_4x4x4_16b_bf16 v[120:123], v[64:65], v[64:65], v[120:123]
    v_mfma_f32_4x4x4_16b_bf16 v[124:127], v[108:109], v[64:65], v[124:127]
    v_mfma_f32_4x4x4_16b_bf16 v[96:99], v[66:67], v[66:67], v[96:99]
    v_mfma_f32_4x4x4_16b_bf16 v[100:103], v[108:109], v[66:67], v[100:103]
    s_cmp_lg_u32 s5, 7
    s_cbranch_scc1 k1m_st2_0
    v_mfma_f32_4x4x4_16b_bf16 v[224:227], v[112:113], v[64:65], v[224:227]
    v_mfma_f32_4x4x4_16b_bf16 v[228:231], v[114:115], v[66:67], v[228:231]
k1m_st2_0:
    s_cmp_lg_u32 s7, 0
    s_cbranch_scc1 k1m_cs2_0
    v_mfma_f32_16x16x32_bf16 v[208:211], v[220:223], v[68:71], v[208:211]
    v_mfma_f32_16x16x32_bf16 v[212:215], v[220:223], v[72:75], v[212:215]
    v_mfma_f32_16x16x32_bf16 v[216:219], v[220:223], v[76:79], v[216:219]
k1m_cs2_0:
    ds_read_b128 v[64:67], v10 offset:32768
    ds_read_b64_tr_b16 v[68:69], v13 offset:12288
    ds_read_b64_tr_b16 v[70:71], v13 offset:13824
    ds_read_b64_tr_b16 v[72:73], v13 offset:12800
    ds_read_b64_tr_b16 v[74:75], v13 offset:14336
    ds_read_b64_tr_b16 v[76:77], v13 offset:13312
    ds_read_b64_tr_b16 v[78:79], v13 offset:14848
    s_waitcnt lgkmcnt(7)
    v_mfma_f32_32x32x16_bf16 v[16:31], v[84:87], v[80:83], v[16:31]
    s_add_u32 m0, s60, 17408
    s_nop 0
    buffer_load_dwordx4 v3, s[8:11], s62 offen lds
    v_mfma_f32_32x32x16_bf16 v[32:47], v[88:91], v[80:83], v[32:47]
    v_mfma_f32_32x32x16_bf16 v[48:63], v[92:95], v[80:83], v[48:63]
    s_cmp_lg_u32 s58, 0
    s_cbranch_scc1 k1m_st2_1
    v_mfma_f32_4x4x4_16b_bf16 v[120:123], v[80:81], v[80:81], v[120:123]
    v_mfma_f32_4x4x4_16b_bf16 v[124:127], v[108:109], v[80:81], v[124:127]
    v_mfma_f32_4x4x4_16b_bf16 v[96:99], v[82:83], v[82:83], v[96:99]
    v_mfma_f32_4x4x4_16b_bf16 v[100:103], v[108:109], v[82:83], v[100:103]
    s_cmp_lg_u32 s5, 7
    s_cbranch_scc1 k1m_st2_1
    v_mfma_f32_4x4x4_16b_bf16 v[224:227], v[116:117], v[80:81], v[224:227]
    v_mfma_f32_4x4x4_16b_bf16 v[228:231], v[118:119], v[82:83], v[228:231]
k1m_st2_1:
    s_cmp_lg_u32 s7, 1
    s_cbranch_scc1 k1m_cs2_1
    v_mfma_f32_16x16x32_bf16 v[208:211], v[220:223], v[84:87], v[208:211]
    v_mfma_f32_16x16x32_bf16 v[212:215], v[220:223], v[88:91], v[212:215]
    v_mfma_f32_16x16x32_bf16 v[216:219], v[220:223], v[92:95], v[216:219]
k1m_cs2_1:
    ds_read_b128 v[80:83], v11 offset:32768
    ds_read_b64_tr_b16 v[84:85], v13 offset:18432
    ds_read_b64_tr_b16 v[86:87], v13 offset:19968
    ds_read_b64_tr_b16 v[88:89], v13 offset:18944
    ds_read_b64_tr_b16 v[90:91], v13 offset:20480
    ds_read_b64_tr_b16 v[92:93], v13 offset:19456
    ds_read_b64_tr_b16 v[94:95], v13 offset:20992
    s_waitcnt lgkmcnt(7)
    v_mfma_f32_32x32x16_bf16 v[16:31], v[68:71], v[64:67], v[16:31]
    s_add_u32 m0, s61, 24576
    s_nop 0
    buffer_load_dwordx4 v4, s[12:15], s63 offen lds
    v_mfma_f32_32x32x16_bf16 v[32:47], v[72:75], v[64:67], v[32:47]
    v_mfma_f32_32x32x16_bf16 v[48:63], v[76:79], v[64:67], v[48:63]
    s_cmp_lg_u32 s58, 1
    s_cbranch_scc1 k1m_st2_2
    v_mfma_f32_4x4x4_16b_bf16 v[120:123], v[64:65], v[64:65], v[120:123]
    v_mfma_f32_4x4x4_16b_bf16 v[124:127], v[108:109], v[64:65], v[124:127]
    v_mfma_f32_4x4x4_16b_bf16 v[96:99], v[66:67], v[66:67], v[96:99]
    v_mfma_f32_4x4x4_16b_bf16 v[100:103], v[108:109], v[66:67], v[100:103]
    s_cmp_lg_u32 s5, 7
    s_cbranch_scc1 k1m_st2_2
    v_mfma_f32_4x4x4_16b_bf16 v[224:227], v[112:113], v[64:65], v[224:227]
    v_mfma_f32_4x4x4_16b_bf16 v[228:231], v[114:115], v[66:67], v[228:231]
k1m_st2_2:
    s_cmp_lg_u32 s7, 2
    s_cbranch_scc1 k1m_cs2_2
    v_mfma_f32_16x16x32_bf16 v[208:211], v[220:223], v[68:71], v[208:211]
    v_mfma_f32_16x16x32_bf16 v[212:215], v[220:223], v[72:75], v[212:215]
    v_mfma_f32_16x16x32_bf16 v[216:219], v[220:223], v[76:79], v[216:219]
k1m_cs2_2:
    s_waitcnt lgkmcnt(0)
    v_mfma_f32_32x32x16_bf16 v[16:31], v[84:87], v[80:83], v[16:31]
    s_add_u32 m0, s61, 25600
    s_nop 0
    buffer_load_dwordx4 v5, s[12:15], s63 offen lds
    v_mfma_f32_32x32x16_bf16 v[32:47], v[88:91], v[80:83], v[32:47]
    v_mfma_f32_32x32x16_bf16 v[48:63], v[92:95], v[80:83], v[48:63]
    s_cmp_lg_u32 s58, 1
    s_cbranch_scc1 k1m_st2_3
    v_mfma_f32_4x4x4_16b_bf16 v[120:123], v[80:81], v[80:81], v[120:123]
    v_mfma_f32_4x4x4_16b_bf16 v[124:127], v[108:109], v[80:81], v[124:127]
    v_mfma_f32_4x4x4_16b_bf16 v[96:99], v[82:83], v[82:83], v[96:99]
    v_mfma_f32_4x4x4_16b_bf16 v[100:103], v[108:109], v[82:83], v[100:103]
    s_cmp_lg_u32 s5, 7
    s_cbranch_scc1 k1m_st2_3
    v_mfma_f32_4x4x4_16b_bf16 v[224:227], v[116:117], v[80:81], v[224:227]
    v_mfma_f32_4x4x4_16b_bf16 v[228:231], v[118:119], v[82:83], v[228:231]
k1m_st2_3:
    s_cmp_lg_u32 s7, 3
    s_cbranch_scc1 k1m_cs2_3
    v_mfma_f32_16x16x32_bf16 v[208:211], v[220:223], v[84:87], v[208:211]
    v_mfma_f32_16x16x32_bf16 v[212:215], v[220:223], v[88:91], v[212:215]
    v_mfma_f32_16x16x32_bf16 v[216:219], v[220:223], v[92:95], v[216:219]
k1m_cs2_3:
    s_add_u32 m0, s61, 26624
    s_nop 0
    buffer_load_dwordx4 v6, s[12:15], s63 offen lds
    s_add_u32 s3, s67, 1048576
    s_mov_b32 m0, s66
    s_nop 0
    buffer_load_dwordx4 v111, s[68:71], s3 offen lds
    s_add_u32 s3, s67, 1310720
    s_mov_b32 m0, s66
    s_nop 0
    buffer_load_dwordx4 v111, s[68:71], s3 offen lds
    s_waitcnt vmcnt(7)
    s_barrier
    s_cmp_lg_u32 s5, 7
    s_cbranch_scc1 k1m_ng3
    ds_read_b128 v[112:115], v107 offset:384
    ds_read_b128 v[116:119], v107 offset:416
k1m_ng3:
    ds_read_b128 v[64:67], v8 offset:0
    ds_read_b64_tr_b16 v[68:69], v12 offset:0
    ds_read_b64_tr_b16 v[70:71], v12 offset:1536
    ds_read_b64_tr_b16 v[72:73], v12 offset:512
    ds_read_b64_tr_b16 v[74:75], v12 offset:2048
    ds_read_b64_tr_b16 v[76:77], v12 offset:1024
    ds_read_b64_tr_b16 v[78:79], v12 offset:2560
    s_mul_i32 s62, s5, 1
    s_add_u32 s62, s62, 5
    s_and_b32 s62, s62, 7
    s_mul_i32 s63, s62, 176128
    s_lshl_b32 s62, s62, 7
    ds_read_b128 v[80:83], v9 offset:0
    ds_read_b64_tr_b16 v[84:85], v12 offset:6144
    ds_read_b64_tr_b16 v[86:87], v12 offset:7680
    ds_read_b64_tr_b16 v[88:89], v12 offset:6656
    ds_read_b64_tr_b16 v[90:91], v12 offset:8192
    ds_read_b64_tr_b16 v[92:93], v12 offset:7168
    ds_read_b64_tr_b16 v[94:95], v12 offset:8704
    s_waitcnt lgkmcnt(7)
    v_mfma_f32_32x32x16_bf16 v[16:31], v[68:71], v[64:67], v[16:31]
    s_add_u32 m0, s60, 32768
    s_nop 0
    buffer_load_dwordx4 v2, s[8:11], s62 offen lds
    v_mfma_f32_32x32x16_bf16 v[32:47], v[72:75], v[64:67], v[32:47]
    v_mfma_f32_32x32x16_bf16 v[48:63], v[76:79], v[64:67], v[48:63]
    s_cmp_lg_u32 s58, 0
    s_cbranch_scc1 k1m_st3_0
    v_mfma_f32_4x4x4_16b_bf16 v[120:123], v[64:65], v[64:65], v[120:123]
    v_mfma_f32_4x4x4_16b_bf16 v[124:127], v[108:109], v[64:65], v[124:127]
    v_mfma_f32_4x4x4_16b_bf16 v[96:99], v[66:67], v[66:67], v[96:99]
    v_mfma_f32_4x4x4_16b_bf16 v[100:103], v[108:109], v[66:67], v[100:103]
    s_cmp_lg_u32 s5, 7
    s_cbranch_scc1 k1m_st3_0
    v_mfma_f32_4x4x4_16b_bf16 v[224:227], v[112:113], v[64:65], v[224:227]
    v_mfma_f32_4x4x4_16b_bf16 v[228:231], v[114:115], v[66:67], v[228:231]
k1m_st3_0:
    s_cmp_lg_u32 s7, 0
    s_cbranch_scc1 k1m_cs3_0
    v_mfma_f32_16x16x32_bf16 v[208:211], v[220:223], v[68:71], v[208:211]
    v_mfma_f32_16x16x32_bf16 v[212:215], v[220:223], v[72:75], v[212:215]
    v_mfma_f32_16x16x32_bf16 v[216:219], v[220:223], v[76:79], v[216:219]
k1m_cs3_0:
    ds_read_b128 v[64:67], v10 offset:0
    ds_read_b64_tr_b16 v[68:69], v12 offset:12288
    ds_read_b64_tr_b16 v[70:71], v12 offset:13824
    ds_read_b64_tr_b16 v[72:73], v12 offset:12800
    ds_read_b64_tr_b16 v[74:75], v12 offset:14336
    ds_read_b64_tr_b16 v[76:77], v12 offset:13312
    ds_read_b64_tr_b16 v[78:79], v12 offset:14848
    s_waitcnt lgkmcnt(7)
    v_mfma_f32_32x32x16_bf16 v[16:31], v[84:87], v[80:83], v[16:31]
    s_add_u32 m0, s60, 33792
    s_nop 0
    buffer_load_dwordx4 v3, s[8:11], s62 offen lds
    v_mfma_f32_32x32x16_bf16 v[32:47], v[88:91], v[80:83], v[32:47]
    v_mfma_f32_32x32x16_bf16 v[48:63], v[92:95], v[80:83], v[48:63]
    s_cmp_lg_u32 s58, 0
    s_cbranch_scc1 k1m_st3_1
    v_mfma_f32_4x4x4_16b_bf16 v[120:123], v[80:81], v[80:81], v[120:123]
    v_mfma_f32_4x4x4_16b_bf16 v[124:127], v[108:109], v[80:81], v[124:127]
    v_mfma_f32_4x4x4_16b_bf16 v[96:99], v[82:83], v[82:83], v[96:99]
    v_mfma_f32_4x4x4_16b_bf16 v[100:103], v[108:109], v[82:83], v[100:103]
    s_cmp_lg_u32 s5, 7
    s_cbranch_scc1 k1m_st3_1
    v_mfma_f32_4x4x4_16b_bf16 v[224:227], v[116:117], v[80:81], v[224:227]
    v_mfma_f32_4x4x4_16b_bf16 v[228:231], v[118:119], v[82:83], v[228:231]
k1m_st3_1:
    s_cmp_lg_u32 s7, 1
    s_cbranch_scc1 k1m_cs3_1
    v_mfma_f32_16x16x32_bf16 v[208:211], v[220:223], v[84:87], v[208:211]
    v_mfma_f32_16x16x32_bf16 v[212:215], v[220:223], v[88:91], v[212:215]
    v_mfma_f32_16x16x32_bf16 v[216:219], v[220:223], v[92:95], v[216:219]
k1m_cs3_1:
    ds_read_b128 v[80:83], v11 offset:0
    ds_read_b64_tr_b16 v[84:85], v12 offset:18432
    ds_read_b64_tr_b16 v[86:87], v12 offset:19968
    ds_read_b64_tr_b16 v[88:89], v12 offset:18944
    ds_read_b64_tr_b16 v[90:91], v12 offset:20480
    ds_read_b64_tr_b16 v[92:93], v12 offset:19456
    ds_read_b64_tr_b16 v[94:95], v12 offset:20992
    s_waitcnt lgkmcnt(7)
    v_mfma_f32_32x32x16_bf16 v[16:31], v[68:71], v[64:67], v[16:31]
    s_add_u32 m0, s61, 49152
    s_nop 0
    buffer_load_dwordx4 v4, s[12:15], s63 offen lds
    v_mfma_f32_32x32x16_bf16 v[32:47], v[72:75], v[64:67], v[32:47]
    v_mfma_f32_32x32x16_bf16 v[48:63], v[76:79], v[64:67], v[48:63]
    s_cmp_lg_u32 s58, 1
    s_cbranch_scc1 k1m_st3_2
    v_mfma_f32_4x4x4_16b_bf16 v[120:123], v[64:65], v[64:65], v[120:123]
    v_mfma_f32_4x4x4_16b_bf16 v[124:127], v[108:109], v[64:65], v[124:127]
    v_mfma_f32_4x4x4_16b_bf16 v[96:99], v[66:67], v[66:67], v[96:99]
    v_mfma_f32_4x4x4_16b_bf16 v[100:103], v[108:109], v[66:67], v[100:103]
    s_cmp_lg_u32 s5, 7
    s_cbranch_scc1 k1m_st3_2
    v_mfma_f32_4x4x4_16b_bf16 v[224:227], v[112:113], v[64:65], v[224:227]
    v_mfma_f32_4x4x4_16b_bf16 v[228:231], v[114:115], v[66:67], v[228:231]
k1m_st3_2:
    s_cmp_lg_u32 s7, 2
    s_cbranch_scc1 k1m_cs3_2
    v_mfma_f32_16x16x32_bf16 v[208:211], v[220:223], v[68:71], v[208:211]
    v_mfma_f32_16x16x32_bf16 v[212:215], v[220:223], v[72:75], v[212:215]
    v_mfma_f32_16x16x32_bf16 v[216:219], v[220:223], v[76:79], v[216:219]
k1m_cs3_2:
    s_waitcnt lgkmcnt(0)
    v_mfma_f32_32x32x16_bf16 v[16:31], v[84:87], v[80:83], v[16:31]
    s_add_u32 m0, s61, 50176
    s_nop 0
    buffer_load_dwordx4 v5, s[12:15], s63 offen lds
    v_mfma_f32_32x32x16_bf16 v[32:47], v[88:91], v[80:83], v[32:47]
    v_mfma_f32_32x32x16_bf16 v[48:63], v[92:95], v[80:83], v[48:63]
    s_cmp_lg_u32 s58, 1
    s_cbranch_scc1 k1m_st3_3
    v_mfma_f32_4x4x4_16b_bf16 v[120:123], v[80:81], v[80:81], v[120:123]
    v_mfma_f32_4x4x4_16b_bf16 v[124:127], v[108:109], v[80:81], v[124:127]
    v_mfma_f32_4x4x4_16b_bf16 v[96:99], v[82:83], v[82:83], v[96:99]
    v_mfma_f32_4x4x4_16b_bf16 v[100:103], v[108:109], v[82:83], v[100:103]
    s_cmp_lg_u32 s5, 7
    s_cbranch_scc1 k1m_st3_3
    v_mfma_f32_4x4x4_16b_bf16 v[224:227], v[116:117], v[80:81], v[224:227]
    v_mfma_f32_4x4x4_16b_bf16 v[228:231], v[118:119], v[82:83], v[228:231]
k1m_st3_3:
    s_cmp_lg_u32 s7, 3
    s_cbranch_scc1 k1m_cs3_3
    v_mfma_f32_16x16x32_bf16 v[208:211], v[220:223], v[84:87], v[208:211]
    v_mfma_f32_16x16x32_bf16 v[212:215], v[220:223], v[88:91], v[212:215]
    v_mfma_f32_16x16x32_bf16 v[216:219], v[220:223], v[92:95], v[216:219]
k1m_cs3_3:
    s_add_u32 m0, s61, 51200
    s_nop 0
    buffer_load_dwordx4 v6, s[12:15], s63 offen lds
    s_add_u32 s3, s67, 0
    s_mov_b32 m0, s66
    s_nop 0
    buffer_load_dwordx4 v111, s[76:79], s3 offen lds
    s_add_u32 s3, s67, 262144
    s_mov_b32 m0, s66
    s_nop 0
    buffer_load_dwordx4 v111, s[76:79], s3 offen lds
    s_waitcnt vmcnt(7)
    s_barrier
    s_cmp_lg_u32 s5, 7
    s_cbranch_scc1 k1m_ng4
    ds_read_b128 v[112:115], v107 offset:512
    ds_read_b128 v[116:119], v107 offset:544
k1m_ng4:
    ds_read_b128 v[64:67], v8 offset:16384
    ds_read_b64_tr_b16 v[68:69], v12 offset:24576
    ds_read_b64_tr_b16 v[70:71], v12 offset:26112
    ds_read_b64_tr_b16 v[72:73], v12 offset:25088
    ds_read_b64_tr_b16 v[74:75], v12 offset:26624
    ds_read_b64_tr_b16 v[76:77], v12 offset:25600
    ds_read_b64_tr_b16 v[78:79], v12 offset:27136
    s_mul_i32 s62, s5, 1
    s_add_u32 s62, s62, 6
    s_and_b32 s62, s62, 7
    s_mul_i32 s63, s62, 176128
    s_lshl_b32 s62, s62, 7
    ds_read_b128 v[80:83], v9 offset:16384
    ds_read_b64_tr_b16 v[84:85], v12 offset:30720
    ds_read_b64_tr_b16 v[86:87], v12 offset:32256
    ds_read_b64_tr_b16 v[88:89], v12 offset:31232
    ds_read_b64_tr_b16 v[90:91], v12 offset:32768
    ds_read_b64_tr_b16 v[92:93], v12 offset:31744
    ds_read_b64_tr_b16 v[94:95], v12 offset:33280
    s_waitcnt lgkmcnt(7)
    v_mfma_f32_32x32x16_bf16 v[16:31], v[68:71], v[64:67], v[16:31]
    s_add_u32 m0, s60, 0
    s_nop 0
    buffer_load_dwordx4 v2, s[8:11], s62 offen lds
    v_mfma_f32_32x32x16_bf16 v[32:47], v[72:75], v[64:67], v[32:47]
    v_mfma_f32_32x32x16_bf16 v[48:63], v[76:79], v[64:67], v[48:63]
    s_cmp_lg_u32 s58, 0
    s_cbranch_scc1 k1m_st4_0
    v_mfma_f32_4x4x4_16b_bf16 v[120:123], v[64:65], v[64:65], v[120:123]
    v_mfma_f32_4x4x4_16b_bf16 v[124:127], v[108:109], v[64:65], v[124:127]
    v_mfma_f32_4x4x4_16b_bf16 v[96:99], v[66:67], v[66:67], v[96:99]
    v_mfma_f32_4x4x4_16b_bf16 v[100:103], v[108:109], v[66:67], v[100:103]
    s_cmp_lg_u32 s5, 7
    s_cbranch_scc1 k1m_st4_0
    v_mfma_f32_4x4x4_16b_bf16 v[224:227], v[112:113], v[64:65], v[224:227]
    v_mfma_f32_4x4x4_16b_bf16 v[228:231], v[114:115], v[66:67], v[228:231]
k1m_st4_0:
    s_cmp_lg_u32 s7, 0
    s_cbranch_scc1 k1m_cs4_0
    v_mfma_f32_16x16x32_bf16 v[208:211], v[220:223], v[68:71], v[208:211]
    v_mfma_f32_16x16x32_bf16 v[212:215], v[220:223], v[72:75], v[212:215]
    v_mfma_f32_16x16x32_bf16 v[216:219], v[220:223], v[76:79], v[216:219]
k1m_cs4_0:
    ds_read_b128 v[64:67], v10 offset:16384
    ds_read_b64_tr_b16 v[68:69], v12 offset:36864
    ds_read_b64_tr_b16 v[70:71], v12 offset:38400
    ds_read_b64_tr_b16 v[72:73], v12 offset:37376
    ds_read_b64_tr_b16 v[74:75], v12 offset:38912
    ds_read_b64_tr_b16 v[76:77], v12 offset:37888
    ds_read_b64_tr_b16 v[78:79], v12 offset:39424
    s_waitcnt lgkmcnt(7)
    v_mfma_f32_32x32x16_bf16 v[16:31], v[84:87], v[80:83], v[16:31]
    s_add_u32 m0, s60, 1024
    s_nop 0
    buffer_load_dwordx4 v3, s[8:11], s62 offen lds
    v_mfma_f32_32x32x16_bf16 v[32:47], v[88:91], v[80:83], v[32:47]
    v_mfma_f32_32x32x16_bf16 v[48:63], v[92:95], v[80:83], v[48:63]
    s_cmp_lg_u32 s58, 0
    s_cbranch_scc1 k1m_st4_1
    v_mfma_f32_4x4x4_16b_bf16 v[120:123], v[80:81], v[80:81], v[120:123]
    v_mfma_f32_4x4x4_16b_bf16 v[124:127], v[108:109], v[80:81], v[124:127]
    v_mfma_f32_4x4x4_16b_bf16 v[96:99], v[82:83], v[82:83], v[96:99]
    v_mfma_f32_4x4x4_16b_bf16 v[100:103], v[108:109], v[82:83], v[100:103]
    s_cmp_lg_u32 s5, 7
    s_cbranch_scc1 k1m_st4_1
    v_mfma_f32_4x4x4_16b_bf16 v[224:227], v[116:117], v[80:81], v[224:227]
    v_mfma_f32_4x4x4_16b_bf16 v[228:231], v[118:119], v[82:83], v[228:231]
k1m_st4_1:
    s_cmp_lg_u32 s7, 1
    s_cbranch_scc1 k1m_cs4_1
    v_mfma_f32_16x16x32_bf16 v[208:211], v[220:223], v[84:87], v[208:211]
    v_mfma_f32_16x16x32_bf16 v[212:215], v[220:223], v[88:91], v[212:215]
    v_mfma_f32_16x16x32_bf16 v[216:219], v[220:223], v[92:95], v[216:219]
k1m_cs4_1:
    ds_read_b128 v[80:83], v11 offset:16384
    ds_read_b64_tr_b16 v[84:85], v12 offset:43008
    ds_read_b64_tr_b16 v[86:87], v12 offset:44544
    ds_read_b64_tr_b16 v[88:89], v12 offset:43520
    ds_read_b64_tr_b16 v[90:91], v12 offset:45056
    ds_read_b64_tr_b16 v[92:93], v12 offset:44032
    ds_read_b64_tr_b16 v[94:95], v12 offset:45568
    s_waitcnt lgkmcnt(7)
    v_mfma_f32_32x32x16_bf16 v[16:31], v[68:71], v[64:67], v[16:31]
    s_add_u32 m0, s61, 0
    s_nop 0
    buffer_load_dwordx4 v4, s[12:15], s63 offen lds
    v_mfma_f32_32x32x16_bf16 v[32:47], v[72:75], v[64:67], v[32:47]
    v_mfma_f32_32x32x16_bf16 v[48:63], v[76:79], v[64:67], v[48:63]
    s_cmp_lg_u32 s58, 1
    s_cbranch_scc1 k1m_st4_2
    v_mfma_f32_4x4x4_16b_bf16 v[120:123], v[64:65], v[64:65], v[120:123]
    v_mfma_f32_4x4x4_16b_bf16 v[124:127], v[108:109], v[64:65], v[124:127]
    v_mfma_f32_4x4x4_16b_bf16 v[96:99], v[66:67], v[66:67], v[96:99]
    v_mfma_f32_4x4x4_16b_bf16 v[100:103], v[108:109], v[66:67], v[100:103]
    s_cmp_lg_u32 s5, 7
    s_cbranch_scc1 k1m_st4_2
    v_mfma_f32_4x4x4_16b_bf16 v[224:227], v[112:113], v[64:65], v[224:227]
    v_mfma_f32_4x4x4_16b_bf16 v[228:231], v[114:115], v[66:67], v[228:231]
k1m_st4_2:
    s_cmp_lg_u32 s7, 2
    s_cbranch_scc1 k1m_cs4_2
    v_mfma_f32_16x16x32_bf16 v[208:211], v[220:223], v[68:71], v[208:211]
    v_mfma_f32_16x16x32_bf16 v[212:215], v[220:223], v[72:75], v[212:215]
    v_mfma_f32_16x16x32_bf16 v[216:219], v[220:223], v[76:79], v[216:219]
k1m_cs4_2:
    s_waitcnt lgkmcnt(0)
    v_mfma_f32_32x32x16_bf16 v[16:31], v[84:87], v[80:83], v[16:31]
    s_add_u32 m0, s61, 1024
    s_nop 0
    buffer_load_dwordx4 v5, s[12:15], s63 offen lds
    v_mfma_f32_32x32x16_bf16 v[32:47], v[88:91], v[80:83], v[32:47]
    v_mfma_f32_32x32x16_bf16 v[48:63], v[92:95], v[80:83], v[48:63]
    s_cmp_lg_u32 s58, 1
    s_cbranch_scc1 k1m_st4_3
    v_mfma_f32_4x4x4_16b_bf16 v[120:123], v[80:81], v[80:81], v[120:123]
    v_mfma_f32_4x4x4_16b_bf16 v[124:127], v[108:109], v[80:81], v[124:127]
    v_mfma_f32_4x4x4_16b_bf16 v[96:99], v[82:83], v[82:83], v[96:99]
    v_mfma_f32_4x4x4_16b_bf16 v[100:103], v[108:109], v[82:83], v[100:103]
    s_cmp_lg_u32 s5, 7
    s_cbranch_scc1 k1m_st4_3
    v_mfma_f32_4x4x4_16b_bf16 v[224:227], v[116:117], v[80:81], v[224:227]
    v_mfma_f32_4x4x4_16b_bf16 v[228:231], v[118:119], v[82:83], v[228:231]
k1m_st4_3:
    s_cmp_lg_u32 s7, 3
    s_cbranch_scc1 k1m_cs4_3
    v_mfma_f32_16x16x32_bf16 v[208:211], v[220:223], v[84:87], v[208:211]
    v_mfma_f32_16x16x32_bf16 v[212:215], v[220:223], v[88:91], v[212:215]
    v_mfma_f32_16x16x32_bf16 v[216:219], v[220:223], v[92:95], v[216:219]
k1m_cs4_3:
    s_add_u32 m0, s61, 2048
    s_nop 0
    buffer_load_dwordx4 v6, s[12:15], s63 offen lds
    s_waitcnt vmcnt(5)
    s_barrier
    s_cmp_lg_u32 s5, 7
    s_cbranch_scc1 k1m_ng5
    ds_read_b128 v[112:115], v107 offset:640
    ds_read_b128 v[116:119], v107 offset:672
k1m_ng5:
    ds_read_b128 v[64:67], v8 offset:32768
    ds_read_b64_tr_b16 v[68:69], v13 offset:0
    ds_read_b64_tr_b16 v[70:71], v13 offset:1536
    ds_read_b64_tr_b16 v[72:73], v13 offset:512
    ds_read_b64_tr_b16 v[74:75], v13 offset:2048
    ds_read_b64_tr_b16 v[76:77], v13 offset:1024
    ds_read_b64_tr_b16 v[78:79], v13 offset:2560
    s_mul_i32 s62, s5, 1
    s_add_u32 s62, s62, 7
    s_and_b32 s62, s62, 7
    s_mul_i32 s63, s62, 176128
    s_lshl_b32 s62, s62, 7
    ds_read_b128 v[80:83], v9 offset:32768
    ds_read_b64_tr_b16 v[84:85], v13 offset:6144
    ds_read_b64_tr_b16 v[86:87], v13 offset:7680
    ds_read_b64_tr_b16 v[88:89], v13 offset:6656
    ds_read_b64_tr_b16 v[90:91], v13 offset:8192
    ds_read_b64_tr_b16 v[92:93], v13 offset:7168
    ds_read_b64_tr_b16 v[94:95], v13 offset:8704
    s_waitcnt lgkmcnt(7)
    v_mfma_f32_32x32x16_bf16 v[16:31], v[68:71], v[64:67], v[16:31]
    s_add_u32 m0, s60, 16384
    s_nop 0
    buffer_load_dwordx4 v2, s[8:11], s62 offen lds
    v_mfma_f32_32x32x16_bf16 v[32:47], v[72:75], v[64:67], v[32:47]
    v_mfma_f32_32x32x16_bf16 v[48:63], v[76:79], v[64:67], v[48:63]
    s_cmp_lg_u32 s58, 0
    s_cbranch_scc1 k1m_st5_0
    v_mfma_f32_4x4x4_16b_bf16 v[120:123], v[64:65], v[64:65], v[120:123]
    v_mfma_f32_4x4x4_16b_bf16 v[124:127], v[108:109], v[64:65], v[124:127]
    v_mfma_f32_4x4x4_16b_bf16 v[96:99], v[66:67], v[66:67], v[96:99]
    v_mfma_f32_4x4x4_16b_bf16 v[100:103], v[108:109], v[66:67], v[100:103]
    s_cmp_lg_u32 s5, 7
    s_cbranch_scc1 k1m_st5_0
    v_mfma_f32_4x4x4_16b_bf16 v[224:227], v[112:113], v[64:65], v[224:227]
    v_mfma_f32_4x4x4_16b_bf16 v[228:231], v[114:115], v[66:67], v[228:231]
k1m_st5_0:
    s_cmp_lg_u32 s7, 0
    s_cbranch_scc1 k1m_cs5_0
    v_mfma_f32_16x16x32_bf16 v[208:211], v[220:223], v[68:71], v[208:211]
    v_mfma_f32_16x16x32_bf16 v[212:215], v[220:223], v[72:75], v[212:215]
    v_mfma_f32_16x16x32_bf16 v[216:219], v[220:223], v[76:79], v[216:219]
k1m_cs5_0:
    ds_read_b128 v[64:67], v10 offset:32768
    ds_read_b64_tr_b16 v[68:69], v13 offset:12288
    ds_read_b64_tr_b16 v[70:71], v13 offset:13824
    ds_read_b64_tr_b16 v[72:73], v13 offset:12800
    ds_read_b64_tr_b16 v[74:75], v13 offset:14336
    ds_read_b64_tr_b16 v[76:77], v13 offset:13312
    ds_read_b64_tr_b16 v[78:79], v13 offset:14848
    s_waitcnt lgkmcnt(7)
    v_mfma_f32_32x32x16_bf16 v[16:31], v[84:87], v[80:83], v[16:31]
    s_add_u32 m0, s60, 17408
    s_nop 0
    buffer_load_dwordx4 v3, s[8:11], s62 offen lds
    v_mfma_f32_32x32x16_bf16 v[32:47], v[88:91], v[80:83], v[32:47]
    v_mfma_f32_32x32x16_bf16 v[48:63], v[92:95], v[80:83], v[48:63]
    s_cmp_lg_u32 s58, 0
    s_cbranch_scc1 k1m_st5_1
    v_mfma_f32_4x4x4_16b_bf16 v[120:123], v[80:81], v[80:81], v[120:123]
    v_mfma_f32_4x4x4_16b_bf16 v[124:127], v[108:109], v[80:81], v[124:127]
    v_mfma_f32_4x4x4_16b_bf16 v[96:99], v[82:83], v[82:83], v[96:99]
    v_mfma_f32_4x4x4_16b_bf16 v[100:103], v[108:109], v[82:83], v[100:103]
    s_cmp_lg_u32 s5, 7
    s_cbranch_scc1 k1m_st5_1
    v_mfma_f32_4x4x4_16b_bf16 v[224:227], v[116:117], v[80:81], v[224:227]
    v_mfma_f32_4x4x4_16b_bf16 v[228:231], v[118:119], v[82:83], v[228:231]
k1m_st5_1:
    s_cmp_lg_u32 s7, 1
    s_cbranch_scc1 k1m_cs5_1
    v_mfma_f32_16x16x32_bf16 v[208:211], v[220:223], v[84:87], v[208:211]
    v_mfma_f32_16x16x32_bf16 v[212:215], v[220:223], v[88:91], v[212:215]
    v_mfma_f32_16x16x32_bf16 v[216:219], v[220:223], v[92:95], v[216:219]
k1m_cs5_1:
    ds_read_b128 v[80:83], v11 offset:32768
    ds_read_b64_tr_b16 v[84:85], v13 offset:18432
    ds_read_b64_tr_b16 v[86:87], v13 offset:19968
    ds_read_b64_tr_b16 v[88:89], v13 offset:18944
    ds_read_b64_tr_b16 v[90:91], v13 offset:20480
    ds_read_b64_tr_b16 v[92:93], v13 offset:19456
    ds_read_b64_tr_b16 v[94:95], v13 offset:20992
    s_waitcnt lgkmcnt(7)
    v_mfma_f32_32x32x16_bf16 v[16:31], v[68:71], v[64:67], v[16:31]
    s_add_u32 m0, s61, 24576
    s_nop 0
    buffer_load_dwordx4 v4, s[12:15], s63 offen lds
    v_mfma_f32_32x32x16_bf16 v[32:47], v[72:75], v[64:67], v[32:47]
    v_mfma_f32_32x32x16_bf16 v[48:63], v[76:79], v[64:67], v[48:63]
    s_cmp_lg_u32 s58, 1
    s_cbranch_scc1 k1m_st5_2
    v_mfma_f32_4x4x4_16b_bf16 v[120:123], v[64:65], v[64:65], v[120:123]
    v_mfma_f32_4x4x4_16b_bf16 v[124:127], v[108:109], v[64:65], v[124:127]
    v_mfma_f32_4x4x4_16b_bf16 v[96:99], v[66:67], v[66:67], v[96:99]
    v_mfma_f32_4x4x4_16b_bf16 v[100:103], v[108:109], v[66:67], v[100:103]
    s_cmp_lg_u32 s5, 7
    s_cbranch_scc1 k1m_st5_2
    v_mfma_f32_4x4x4_16b_bf16 v[224:227], v[112:113], v[64:65], v[224:227]
    v_mfma_f32_4x4x4_16b_bf16 v[228:231], v[114:115], v[66:67], v[228:231]
k1m_st5_2:
    s_cmp_lg_u32 s7, 2
    s_cbranch_scc1 k1m_cs5_2
    v_mfma_f32_16x16x32_bf16 v[208:211], v[220:223], v[68:71], v[208:211]
    v_mfma_f32_16x16x32_bf16 v[212:215], v[220:223], v[72:75], v[212:215]
    v_mfma_f32_16x16x32_bf16 v[216:219], v[220:223], v[76:79], v[216:219]
k1m_cs5_2:
    s_waitcnt lgkmcnt(0)
    v_mfma_f32_32x32x16_bf16 v[16:31], v[84:87], v[80:83], v[16:31]
    s_add_u32 m0, s61, 25600
    s_nop 0
    buffer_load_dwordx4 v5, s[12:15], s63 offen lds
    v_mfma_f32_32x32x16_bf16 v[32:47], v[88:91], v[80:83], v[32:47]
    v_mfma_f32_32x32x16_bf16 v[48:63], v[92:95], v[80:83], v[48:63]
    s_cmp_lg_u32 s58, 1
    s_cbranch_scc1 k1m_st5_3
    v_mfma_f32_4x4x4_16b_bf16 v[120:123], v[80:81], v[80:81], v[120:123]
    v_mfma_f32_4x4x4_16b_bf16 v[124:127], v[108:109], v[80:81], v[124:127]
    v_mfma_f32_4x4x4_16b_bf16 v[96:99], v[82:83], v[82:83], v[96:99]
    v_mfma_f32_4x4x4_16b_bf16 v[100:103], v[108:109], v[82:83], v[100:103]
    s_cmp_lg_u32 s5, 7
    s_cbranch_scc1 k1m_st5_3
    v_mfma_f32_4x4x4_16b_bf16 v[224:227], v[116:117], v[80:81], v[224:227]
    v_mfma_f32_4x4x4_16b_bf16 v[228:231], v[118:119], v[82:83], v[228:231]
k1m_st5_3:
    s_cmp_lg_u32 s7, 3
    s_cbranch_scc1 k1m_cs5_3
    v_mfma_f32_16x16x32_bf16 v[208:211], v[220:223], v[84:87], v[208:211]
    v_mfma_f32_16x16x32_bf16 v[212:215], v[220:223], v[88:91], v[212:215]
    v_mfma_f32_16x16x32_bf16 v[216:219], v[220:223], v[92:95], v[216:219]
k1m_cs5_3:
    s_add_u32 m0, s61, 26624
    s_nop 0
    buffer_load_dwordx4 v6, s[12:15], s63 offen lds
    s_waitcnt vmcnt(5)
    s_barrier
    s_cmp_lg_u32 s5, 7
    s_cbranch_scc1 k1m_ng6
    ds_read_b128 v[112:115], v107 offset:768
    ds_read_b128 v[116:119], v107 offset:800
k1m_ng6:
    ds_read_b128 v[64:67], v8 offset:0
    ds_read_b64_tr_b16 v[68:69], v12 offset:0
    ds_read_b64_tr_b16 v[70:71], v12 offset:1536
    ds_read_b64_tr_b16 v[72:73], v12 offset:512
    ds_read_b64_tr_b16 v[74:75], v12 offset:2048
    ds_read_b64_tr_b16 v[76:77], v12 offset:1024
    ds_read_b64_tr_b16 v[78:79], v12 offset:2560
    ds_read_b128 v[80:83], v9 offset:0
    ds_read_b64_tr_b16 v[84:85], v12 offset:6144
    ds_read_b64_tr_b16 v[86:87], v12 offset:7680
    ds_read_b64_tr_b16 v[88:89], v12 offset:6656
    ds_read_b64_tr_b16 v[90:91], v12 offset:8192
    ds_read_b64_tr_b16 v[92:93], v12 offset:7168
    ds_read_b64_tr_b16 v[94:95], v12 offset:8704
    s_waitcnt lgkmcnt(7)
    v_mfma_f32_32x32x16_bf16 v[16:31], v[68:71], v[64:67], v[16:31]
    v_mfma_f32_32x32x16_bf16 v[32:47], v[72:75], v[64:67], v[32:47]
    v_mfma_f32_32x32x16_bf16 v[48:63], v[76:79], v[64:67], v[48:63]
    s_cmp_lg_u32 s58, 0
    s_cbranch_scc1 k1m_st6_0
    v_mfma_f32_4x4x4_16b_bf16 v[120:123], v[64:65], v[64:65], v[120:123]
    v_mfma_f32_4x4x4_16b_bf16 v[124:127], v[108:109], v[64:65], v[124:127]
    v_mfma_f32_4x4x4_16b_bf16 v[96:99], v[66:67], v[66:67], v[96:99]
    v_mfma_f32_4x4x4_16b_bf16 v[100:103], v[108:109], v[66:67], v[100:103]
    s_cmp_lg_u32 s5, 7
    s_cbranch_scc1 k1m_st6_0
    v_mfma_f32_4x4x4_16b_bf16 v[224:227], v[112:113], v[64:65], v[224:227]
    v_mfma_f32_4x4x4_16b_bf16 v[228:231], v[114:115], v[66:67], v[228:231]
k1m_st6_0:
    s_cmp_lg_u32 s7, 0
    s_cbranch_scc1 k1m_cs6_0
    v_mfma_f32_16x16x32_bf16 v[208:211], v[220:223], v[68:71], v[208:211]
    v_mfma_f32_16x16x32_bf16 v[212:215], v[220:223], v[72:75], v[212:215]
    v_mfma_f32_16x16x32_bf16 v[216:219], v[220:223], v[76:79], v[216:219]
k1m_cs6_0:
    ds_read_b128 v[64:67], v10 offset:0
    ds_read_b64_tr_b16 v[68:69], v12 offset:12288
    ds_read_b64_tr_b16 v[70:71], v12 offset:13824
    ds_read_b64_tr_b16 v[72:73], v12 offset:12800
    ds_read_b64_tr_b16 v[74:75], v12 offset:14336
    ds_read_b64_tr_b16 v[76:77], v12 offset:13312
    ds_read_b64_tr_b16 v[78:79], v12 offset:14848
    s_waitcnt lgkmcnt(7)
    v_mfma_f32_32x32x16_bf16 v[16:31], v[84:87], v[80:83], v[16:31]
    v_mfma_f32_32x32x16_bf16 v[32:47], v[88:91], v[80:83], v[32:47]
    v_mfma_f32_32x32x16_bf16 v[48:63], v[92:95], v[80:83], v[48:63]
    s_cmp_lg_u32 s58, 0
    s_cbranch_scc1 k1m_st6_1
    v_mfma_f32_4x4x4_16b_bf16 v[120:123], v[80:81], v[80:81], v[120:123]
    v_mfma_f32_4x4x4_16b_bf16 v[124:127], v[108:109], v[80:81], v[124:127]
    v_mfma_f32_4x4x4_16b_bf16 v[96:99], v[82:83], v[82:83], v[96:99]
    v_mfma_f32_4x4x4_16b_bf16 v[100:103], v[108:109], v[82:83], v[100:103]
    s_cmp_lg_u32 s5, 7
    s_cbranch_scc1 k1m_st6_1
    v_mfma_f32_4x4x4_16b_bf16 v[224:227], v[116:117], v[80:81], v[224:227]
    v_mfma_f32_4x4x4_16b_bf16 v[228:231], v[118:119], v[82:83], v[228:231]
k1m_st6_1:
    s_cmp_lg_u32 s7, 1
    s_cbranch_scc1 k1m_cs6_1
    v_mfma_f32_16x16x32_bf16 v[208:211], v[220:223], v[84:87], v[208:211]
    v_mfma_f32_16x16x32_bf16 v[212:215], v[220:223], v[88:91], v[212:215]
    v_mfma_f32_16x16x32_bf16 v[216:219], v[220:223], v[92:95], v[216:219]
k1m_cs6_1:
    ds_read_b128 v[80:83], v11 offset:0
    ds_read_b64_tr_b16 v[84:85], v12 offset:18432
    ds_read_b64_tr_b16 v[86:87], v12 offset:19968
    ds_read_b64_tr_b16 v[88:89], v12 offset:18944
    ds_read_b64_tr_b16 v[90:91], v12 offset:20480
    ds_read_b64_tr_b16 v[92:93], v12 offset:19456
    ds_read_b64_tr_b16 v[94:95], v12 offset:20992
    s_waitcnt lgkmcnt(7)
    v_mfma_f32_32x32x16_bf16 v[16:31], v[68:71], v[64:67], v[16:31]
    v_mfma_f32_32x32x16_bf16 v[32:47], v[72:75], v[64:67], v[32:47]
    v_mfma_f32_32x32x16_bf16 v[48:63], v[76:79], v[64:67], v[48:63]
    s_cmp_lg_u32 s58, 1
    s_cbranch_scc1 k1m_st6_2
    v_mfma_f32_4x4x4_16b_bf16 v[120:123], v[64:65], v[64:65], v[120:123]
    v_mfma_f32_4x4x4_16b_bf16 v[124:127], v[108:109], v[64:65], v[124:127]
    v_mfma_f32_4x4x4_16b_bf16 v[96:99], v[66:67], v[66:67], v[96:99]
    v_mfma_f32_4x4x4_16b_bf16 v[100:103], v[108:109], v[66:67], v[100:103]
    s_cmp_lg_u32 s5, 7
    s_cbranch_scc1 k1m_st6_2
    v_mfma_f32_4x4x4_16b_bf16 v[224:227], v[112:113], v[64:65], v[224:227]
    v_mfma_f32_4x4x4_16b_bf16 v[228:231], v[114:115], v[66:67], v[228:231]
k1m_st6_2:
    s_cmp_lg_u32 s7, 2
    s_cbranch_scc1 k1m_cs6_2
    v_mfma_f32_16x16x32_bf16 v[208:211], v[220:223], v[68:71], v[208:211]
    v_mfma_f32_16x16x32_bf16 v[212:215], v[220:223], v[72:75], v[212:215]
    v_mfma_f32_16x16x32_bf16 v[216:219], v[220:223], v[76:79], v[216:219]
k1m_cs6_2:
    s_waitcnt lgkmcnt(0)
    v_mfma_f32_32x32x16_bf16 v[16:31], v[84:87], v[80:83], v[16:31]
    v_mfma_f32_32x32x16_bf16 v[32:47], v[88:91], v[80:83], v[32:47]
    v_mfma_f32_32x32x16_bf16 v[48:63], v[92:95], v[80:83], v[48:63]
    s_cmp_lg_u32 s58, 1
    s_cbranch_scc1 k1m_st6_3
    v_mfma_f32_4x4x4_16b_bf16 v[120:123], v[80:81], v[80:81], v[120:123]
    v_mfma_f32_4x4x4_16b_bf16 v[124:127], v[108:109], v[80:81], v[124:127]
    v_mfma_f32_4x4x4_16b_bf16 v[96:99], v[82:83], v[82:83], v[96:99]
    v_mfma_f32_4x4x4_16b_bf16 v[100:103], v[108:109], v[82:83], v[100:103]
    s_cmp_lg_u32 s5, 7
    s_cbranch_scc1 k1m_st6_3
    v_mfma_f32_4x4x4_16b_bf16 v[224:227], v[116:117], v[80:81], v[224:227]
    v_mfma_f32_4x4x4_16b_bf16 v[228:231], v[118:119], v[82:83], v[228:231]
k1m_st6_3:
    s_cmp_lg_u32 s7, 3
    s_cbranch_scc1 k1m_cs6_3
    v_mfma_f32_16x16x32_bf16 v[208:211], v[220:223], v[84:87], v[208:211]
    v_mfma_f32_16x16x32_bf16 v[212:215], v[220:223], v[88:91], v[212:215]
    v_mfma_f32_16x16x32_bf16 v[216:219], v[220:223], v[92:95], v[216:219]
k1m_cs6_3:
    s_cmp_lg_u32 s6, 0
    s_cbranch_scc1 k1m_noprobe
    buffer_load_dword v249, v251, s[72:75], 0 offen sc1
k1m_noprobe:
    s_waitcnt vmcnt(0)
    s_barrier
    s_cmp_lg_u32 s5, 7
    s_cbranch_scc1 k1m_ng7
    ds_read_b128 v[112:115], v107 offset:896
    ds_read_b128 v[116:119], v107 offset:928
k1m_ng7:
    ds_read_b128 v[64:67], v8 offset:16384
    ds_read_b64_tr_b16 v[68:69], v12 offset:24576
    ds_read_b64_tr_b16 v[70:71], v12 offset:26112
    ds_read_b64_tr_b16 v[72:73], v12 offset:25088
    ds_read_b64_tr_b16 v[74:75], v12 offset:26624
    ds_read_b64_tr_b16 v[76:77], v12 offset:25600
    ds_read_b64_tr_b16 v[78:79], v12 offset:27136
    ds_read_b128 v[80:83], v9 offset:16384
    ds_read_b64_tr_b16 v[84:85], v12 offset:30720
    ds_read_b64_tr_b16 v[86:87], v12 offset:32256
    ds_read_b64_tr_b16 v[88:89], v12 offset:31232
    ds_read_b64_tr_b16 v[90:91], v12 offset:32768
    ds_read_b64_tr_b16 v[92:93], v12 offset:31744
    ds_read_b64_tr_b16 v[94:95], v12 offset:33280
    s_waitcnt lgkmcnt(7)
    v_mfma_f32_32x32x16_bf16 v[16:31], v[68:71], v[64:67], v[16:31]
    v_mfma_f32_32x32x16_bf16 v[32:47], v[72:75], v[64:67], v[32:47]
    v_mfma_f32_32x32x16_bf16 v[48:63], v[76:79], v[64:67], v[48:63]
    s_cmp_lg_u32 s58, 0
    s_cbranch_scc1 k1m_st7_0
    v_mfma_f32_4x4x4_16b_bf16 v[120:123], v[64:65], v[64:65], v[120:123]
    v_mfma_f32_4x4x4_16b_bf16 v[124:127], v[108:109], v[64:65], v[124:127]
    v_mfma_f32_4x4x4_16b_bf16 v[96:99], v[66:67], v[66:67], v[96:99]
    v_mfma_f32_4x4x4_16b_bf16 v[100:103], v[108:109], v[66:67], v[100:103]
    s_cmp_lg_u32 s5, 7
    s_cbranch_scc1 k1m_st7_0
    v_mfma_f32_4x4x4_16b_bf16 v[224:227], v[112:113], v[64:65], v[224:227]
    v_mfma_f32_4x4x4_16b_bf16 v[228:231], v[114:115], v[66:67], v[228:231]
k1m_st7_0:
    s_cmp_lg_u32 s7, 0
    s_cbranch_scc1 k1m_cs7_0
    v_mfma_f32_16x16x32_bf16 v[208:211], v[220:223], v[68:71], v[208:211]
    v_mfma_f32_16x16x32_bf16 v[212:215], v[220:223], v[72:75], v[212:215]
    v_mfma_f32_16x16x32_bf16 v[216:219], v[220:223], v[76:79], v[216:219]
k1m_cs7_0:
    ds_read_b128 v[64:67], v10 offset:16384
    ds_read_b64_tr_b16 v[68:69], v12 offset:36864
    ds_read_b64_tr_b16 v[70:71], v12 offset:38400
    ds_read_b64_tr_b16 v[72:73], v12 offset:37376
    ds_read_b64_tr_b16 v[74:75], v12 offset:38912
    ds_read_b64_tr_b16 v[76:77], v12 offset:37888
    ds_read_b64_tr_b16 v[78:79], v12 offset:39424
    s_waitcnt lgkmcnt(7)
    v_mfma_f32_32x32x16_bf16 v[16:31], v[84:87], v[80:83], v[16:31]
    v_mfma_f32_32x32x16_bf16 v[32:47], v[88:91], v[80:83], v[32:47]
    v_mfma_f32_32x32x16_bf16 v[48:63], v[92:95], v[80:83], v[48:63]
    s_cmp_lg_u32 s58, 0
    s_cbranch_scc1 k1m_st7_1
    v_mfma_f32_4x4x4_16b_bf16 v[120:123], v[80:81], v[80:81], v[120:123]
    v_mfma_f32_4x4x4_16b_bf16 v[124:127], v[108:109], v[80:81], v[124:127]
    v_mfma_f32_4x4x4_16b_bf16 v[96:99], v[82:83], v[82:83], v[96:99]
    v_mfma_f32_4x4x4_16b_bf16 v[100:103], v[108:109], v[82:83], v[100:103]
    s_cmp_lg_u32 s5, 7
    s_cbranch_scc1 k1m_st7_1
    v_mfma_f32_4x4x4_16b_bf16 v[224:227], v[116:117], v[80:81], v[224:227]
    v_mfma_f32_4x4x4_16b_bf16 v[228:231], v[118:119], v[82:83], v[228:231]
k1m_st7_1:
    s_cmp_lg_u32 s7, 1
    s_cbranch_scc1 k1m_cs7_1
    v_mfma_f32_16x16x32_bf16 v[208:211], v[220:223], v[84:87], v[208:211]
    v_mfma_f32_16x16x32_bf16 v[212:215], v[220:223], v[88:91], v[212:215]
    v_mfma_f32_16x16x32_bf16 v[216:219], v[220:223], v[92:95], v[216:219]
k1m_cs7_1:
    ds_read_b128 v[80:83], v11 offset:16384
    ds_read_b64_tr_b16 v[84:85], v12 offset:43008
    ds_read_b64_tr_b16 v[86:87], v12 offset:44544
    ds_read_b64_tr_b16 v[88:89], v12 offset:43520
    ds_read_b64_tr_b16 v[90:91], v12 offset:45056
    ds_read_b64_tr_b16 v[92:93], v12 offset:44032
    ds_read_b64_tr_b16 v[94:95], v12 offset:45568
    s_waitcnt lgkmcnt(7)
    v_mfma_f32_32x32x16_bf16 v[16:31], v[68:71], v[64:67], v[16:31]
    v_mfma_f32_32x32x16_bf16 v[32:47], v[72:75], v[64:67], v[32:47]
    v_mfma_f32_32x32x16_bf16 v[48:63], v[76:79], v[64:67], v[48:63]
    s_cmp_lg_u32 s58, 1
    s_cbranch_scc1 k1m_st7_2
    v_mfma_f32_4x4x4_16b_bf16 v[120:123], v[64:65], v[64:65], v[120:123]
    v_mfma_f32_4x4x4_16b_bf16 v[124:127], v[108:109], v[64:65], v[124:127]
    v_mfma_f32_4x4x4_16b_bf16 v[96:99], v[66:67], v[66:67], v[96:99]
    v_mfma_f32_4x4x4_16b_bf16 v[100:103], v[108:109], v[66:67], v[100:103]
    s_cmp_lg_u32 s5, 7
    s_cbranch_scc1 k1m_st7_2
    v_mfma_f32_4x4x4_16b_bf16 v[224:227], v[112:113], v[64:65], v[224:227]
    v_mfma_f32_4x4x4_16b_bf16 v[228:231], v[114:115], v[66:67], v[228:231]
k1m_st7_2:
    s_cmp_lg_u32 s7, 2
    s_cbranch_scc1 k1m_cs7_2
    v_mfma_f32_16x16x32_bf16 v[208:211], v[220:223], v[68:71], v[208:211]
    v_mfma_f32_16x16x32_bf16 v[212:215], v[220:223], v[72:75], v[212:215]
    v_mfma_f32_16x16x32_bf16 v[216:219], v[220:223], v[76:79], v[216:219]
k1m_cs7_2:
    s_waitcnt lgkmcnt(0)
    v_mfma_f32_32x32x16_bf16 v[16:31], v[84:87], v[80:83], v[16:31]
    v_mfma_f32_32x32x16_bf16 v[32:47], v[88:91], v[80:83], v[32:47]
    v_mfma_f32_32x32x16_bf16 v[48:63], v[92:95], v[80:83], v[48:63]
    s_cmp_lg_u32 s58, 1
    s_cbranch_scc1 k1m_st7_3
    v_mfma_f32_4x4x4_16b_bf16 v[120:123], v[80:81], v[80:81], v[120:123]
    v_mfma_f32_4x4x4_16b_bf16 v[124:127], v[108:109], v[80:81], v[124:127]
    v_mfma_f32_4x4x4_16b_bf16 v[96:99], v[82:83], v[82:83], v[96:99]
    v_mfma_f32_4x4x4_16b_bf16 v[100:103], v[108:109], v[82:83], v[100:103]
    s_cmp_lg_u32 s5, 7
    s_cbranch_scc1 k1m_st7_3
    v_mfma_f32_4x4x4_16b_bf16 v[224:227], v[116:117], v[80:81], v[224:227]
    v_mfma_f32_4x4x4_16b_bf16 v[228:231], v[118:119], v[82:83], v[228:231]
k1m_st7_3:
    s_cmp_lg_u32 s7, 3
    s_cbranch_scc1 k1m_cs7_3
    v_mfma_f32_16x16x32_bf16 v[208:211], v[220:223], v[84:87], v[208:211]
    v_mfma_f32_16x16x32_bf16 v[212:215], v[220:223], v[88:91], v[212:215]
    v_mfma_f32_16x16x32_bf16 v[216:219], v[220:223], v[92:95], v[216:219]
k1m_cs7_3:
    s_barrier
    s_mov_b32 s8, s46
    s_mov_b32 s9, s47
    s_mov_b32 s10, 1409024
    s_mov_b32 s11, 0x00020000
    v_bfe_u32 v250, v1, 2, 2
    v_lshl_add_u32 v250, v15, 2, v250
    v_lshlrev_b32 v250, 10, v250
    v_bfe_u32 v252, v1, 4, 1
    v_lshl_add_u32 v250, v252, 6, v250
    v_and_b32 v252, 3, v1
    v_lshl_add_u32 v250, v252, 4, v250
    s_lshr_b32 s3, s2, 3
    s_and_b32 s3, s3, 7
    s_lshl_b32 s3, s3, 7
    v_add_u32 v250, s3, v250
    s_lshl_b32 s68, s6, 11
    s_cmp_lt_u32 s6, 2
    s_cselect_b32 s3, 8, 0
    s_sub_u32 s3, s6, s3
    s_sub_u32 s33, s3, 82
    s_sub_u32 s34, s3, 162
    s_mov_b32 s32, s6
    s_cmp_lt_u32 s6, 2
    s_cselect_b32 s35, s32, s33
    s_cselect_b32 s36, s33, s34
    s_lshl_b32 s32, s32, 14
    s_lshl_b32 s33, s33, 14
    s_lshl_b32 s34, s34, 14
    s_lshl_b32 s35, s35, 14
    s_lshl_b32 s36, s36, 14
    s_add_u32 s16, s56, 12713984
    s_addc_u32 s17, s57, 0
    s_mov_b32 s18, 8192
    s_mov_b32 s19, 0x00020000
    s_and_b32 s3, s2, 7
    s_lshr_b32 s59, s2, 6
    s_lshl_b32 s60, s3, 2
    s_add_u32 s60, s60, s59
    s_mul_i32 s60, s60, 256
    v_lshl_add_u32 v244, v1, 2, s60
    v_mov_b32 v245, 8
    v_mov_b32 v247, 128
    v_cmp_eq_u32 vcc, 4, v1
    s_nop 1
    v_cndmask_b32 v245, v245, v247, vcc
    v_mov_b32 v9, 155648
    v_mov_b32 v10, 1
    s_cmp_ge_u32 s6, 4
    s_cbranch_scc1 k1m_noearly
    s_add_u32 s76, s32, 0
    s_add_u32 m0, s68, 65536
    s_nop 0
    buffer_load_dwordx4 v250, s[8:11], s76 offen lds
    s_add_u32 s76, s76, 8192
    s_add_u32 m0, s68, 66560
    s_nop 0
    buffer_load_dwordx4 v250, s[8:11], s76 offen lds
    s_add_u32 s76, s32, 196608
    s_add_u32 m0, s68, 73728
    s_nop 0
    buffer_load_dwordx4 v250, s[8:11], s76 offen lds
    s_add_u32 s76, s76, 8192
    s_add_u32 m0, s68, 74752
    s_nop 0
    buffer_load_dwordx4 v250, s[8:11], s76 offen lds
    s_add_u32 s76, s32, 393216
    s_add_u32 m0, s68, 81920
    s_nop 0
    buffer_load_dwordx4 v250, s[8:11], s76 offen lds
    s_add_u32 s76, s76, 8192
    s_add_u32 m0, s68, 82944
    s_nop 0
    buffer_load_dwordx4 v250, s[8:11], s76 offen lds
    s_add_u32 s76, s32, 589824
    s_add_u32 m0, s68, 90112
    s_nop 0
    buffer_load_dwordx4 v250, s[8:11], s76 offen lds
    s_add_u32 s76, s76, 8192
    s_add_u32 m0, s68, 91136
    s_nop 0
    buffer_load_dwordx4 v250, s[8:11], s76 offen lds
    s_add_u32 s76, s32, 786432
    s_add_u32 m0, s68, 98304
    s_nop 0
    buffer_load_dwordx4 v250, s[8:11], s76 offen lds
    s_add_u32 s76, s76, 8192
    s_add_u32 m0, s68, 99328
    s_nop 0
    buffer_load_dwordx4 v250, s[8:11], s76 offen lds
    s_add_u32 s76, s32, 983040
    s_add_u32 m0, s68, 106496
    s_nop 0
    buffer_load_dwordx4 v250, s[8:11], s76 offen lds
    s_add_u32 s76, s76, 8192
    s_add_u32 m0, s68, 107520
    s_nop 0
    buffer_load_dwordx4 v250, s[8:11], s76 offen lds
    s_add_u32 s76, s32, 1179648
    s_add_u32 m0, s68, 114688
    s_nop 0
    buffer_load_dwordx4 v250, s[8:11], s76 offen lds
    s_add_u32 s76, s76, 8192
    s_add_u32 m0, s68, 115712
    s_nop 0
    buffer_load_dwordx4 v250, s[8:11], s76 offen lds
    s_add_u32 s76, s35, 1376256
    s_add_u32 m0, s68, 122880
    s_nop 0
    buffer_load_dwordx4 v250, s[8:11], s76 offen lds
    s_add_u32 s76, s76, 8192
    s_add_u32 m0, s68, 123904
    s_nop 0
    buffer_load_dwordx4 v250, s[8:11], s76 offen lds
    s_add_u32 s76, s33, 1572864
    s_add_u32 m0, s68, 131072
    s_nop 0
    buffer_load_dwordx4 v250, s[8:11], s76 offen lds
    s_add_u32 s76, s76, 8192
    s_add_u32 m0, s68, 132096
    s_nop 0
    buffer_load_dwordx4 v250, s[8:11], s76 offen lds
    s_add_u32 s76, s33, 1769472
    s_add_u32 m0, s68, 139264
    s_nop 0
    buffer_load_dwordx4 v250, s[8:11], s76 offen lds
    s_add_u32 s76, s76, 8192
    s_add_u32 m0, s68, 140288
    s_nop 0
    buffer_load_dwordx4 v250, s[8:11], s76 offen lds
    s_add_u32 s76, s33, 1966080
    s_add_u32 m0, s68, 147456
    s_nop 0
    buffer_load_dwordx4 v250, s[8:11], s76 offen lds
    s_add_u32 s76, s76, 8192
    s_add_u32 m0, s68, 148480
    s_nop 0
    buffer_load_dwordx4 v250, s[8:11], s76 offen lds
    s_cmp_lg_u32 s6, 0
    s_cbranch_scc1 k1m_noearly
    v_cmp_ne_u32 vcc, 0, v249
    s_nop 0
    s_cmp_eq_u64 vcc, -1
    s_cbranch_scc1 k1m_noearly
    s_mov_b32 s79, 0
pl_k1m_init:
    buffer_load_dword v249, v251, s[72:75], 0 offen sc1
    s_waitcnt vmcnt(0)
    v_cmp_ne_u32 vcc, 0, v249
    s_nop 0
    s_cmp_eq_u64 vcc, -1
    s_cbranch_scc1 pd_k1m_init
    s_add_u32 s79, s79, 1
    s_cmp_lt_u32 s79, 65536
    s_cbranch_scc0 pd_k1m_init
    s_sleep 1
    s_branch pl_k1m_init
pd_k1m_init:
k1m_noearly:
    s_nop 7
    s_nop 7
    v_and_b32 v132, 15, v1
    v_and_b32 v133, 3, v1
    v_add_f32 v120, v120, v96
    v_add_f32 v121, v121, v97
    v_add_f32 v122, v122, v98
    v_add_f32 v123, v123, v99
    v_add_f32 v134, v124, v100
    v_mov_b32 v135, v120
    v_cmp_eq_u32 vcc, 1, v133
    s_nop 1
    v_cndmask_b32 v135, v135, v121, vcc
    v_cmp_eq_u32 vcc, 2, v133
    s_nop 1
    v_cndmask_b32 v135, v135, v122, vcc
    v_cmp_eq_u32 vcc, 3, v133
    s_nop 1
    v_cndmask_b32 v135, v135, v123, vcc
    s_lshl_b32 s3, s7, 5
    v_add_u32 v137, s3, v7
    s_lshl_b32 s3, s58, 1
    v_add_u32 v138, s3, v15
    v_lshlrev_b32 v138, 7, v138
    v_add_u32 v138, v138, v137
    v_lshlrev_b32 v139, 3, v138
    ds_write_b64 v139, v[134:135] offset:12288
    v_add_f32 v224, v224, v228
    v_lshlrev_b32 v139, 2, v138
    ds_write_b32 v139, v224 offset:16384
    v_lshlrev_b32 v136, 2, v1
    v_add_u32 v136, 1024, v136
    v_cmp_gt_u32 vcc, 16, v1
    s_mul_i32 s3, s6, 384
    s_add_u32 s3, s3, 2048
    v_lshl_add_u32 v139, v132, 2, s3
    v_cndmask_b32 v139, v136, v139, vcc
    ds_write_b32 v139, v208 offset:0
    ds_write_b32 v139, v209 offset:64
    ds_write_b32 v139, v212 offset:128
    ds_write_b32 v139, v213 offset:192
    ds_write_b32 v139, v216 offset:256
    ds_write_b32 v139, v217 offset:320
    s_waitcnt lgkmcnt(0)
    s_barrier
    v_lshlrev_b32 v134, 3, v137
    ds_read_b64 v[96:97], v134 offset:12288
    ds_read_b64 v[98:99], v134 offset:13312
    ds_read_b64 v[100:101], v134 offset:14336
    ds_read_b64 v[102:103], v134 offset:15360
    s_cmp_lg_u32 s5, 7
    s_cbranch_scc1 k1m_nog
    s_cmp_lg_u32 s58, 0
    s_cbranch_scc1 k1m_nog
    v_lshlrev_b32 v139, 2, v137
    ds_read_b32 v124, v139 offset:16384
    ds_read_b32 v125, v139 offset:16896
    ds_read_b32 v126, v139 offset:17408
    ds_read_b32 v127, v139 offset:17920
    s_add_u32 s20, s56, 12648448
    s_addc_u32 s21, s57, 0
    s_mov_b32 s22, 8192
    s_mov_b32 s23, 0x00020000
    s_mov_b32 s65, 1069066811
    s_waitcnt lgkmcnt(0)
    v_add_f32 v124, v124, v125
    v_add_f32 v126, v126, v127
    v_add_f32 v125, v124, v126
    v_mul_f32 v125, s65, v125
    v_exp_f32 v125, -v125
    s_nop 0
    v_add_f32 v125, 1.0, v125
    v_rcp_f32 v125, v125
    s_lshl_b32 s3, s4, 7
    v_add_u32 v139, s3, v137
    v_lshlrev_b32 v139, 2, v139
    v_mov_b32 v140, 0x100000
    v_cmp_gt_u32 vcc, 32, v1
    s_nop 1
    v_cndmask_b32 v139, v140, v139, vcc
    buffer_store_dword v125, v139, s[20:23], 0 offen sc1
k1m_nog:
    v_min_u32 v135, 47, v1
    v_lshlrev_b32 v135, 3, v135
    s_mul_i32 s3, s58, 1536
    v_add_u32 v136, s3, v135
    ds_read_b64 v[140:141], v136 offset:2048
    ds_read_b64 v[142:143], v136 offset:2432
    ds_read_b64 v[144:145], v136 offset:2816
    ds_read_b64 v[146:147], v136 offset:3200
    s_waitcnt lgkmcnt(0)
    v_add_f32 v96, v96, v98
    v_add_f32 v97, v97, v99
    v_add_f32 v100, v100, v102
    v_add_f32 v101, v101, v103
    v_add_f32 v104, v96, v100
    v_add_f32 v105, v97, v101
    v_add_f32 v140, v140, v142
    v_add_f32 v141, v141, v143
    v_add_f32 v144, v144, v146
    v_add_f32 v145, v145, v147
    v_add_f32 v140, v140, v144
    v_add_f32 v141, v141, v145
    s_lshl_b32 s3, s6, 9
    s_add_u32 s3, s3, 8192
    v_add_u32 v136, s3, v135
    ds_write_b64 v136, v[140:141]
    v_mul_f32 v104, 989855744, v104
    v_mul_f32 v105, 989855744, v105
    v_fma_f32 v105, -v104, v104, v105
    v_max_f32 v105, 0, v105
    v_add_f32 v105, 925353388, v105
    v_rsq_f32 v13, v105
    s_nop 0
    v_mul_f32 v12, v104, v13
    v_lshlrev_b32 v134, 4, v15
    v_add_u32 v134, s3, v134
    s_waitcnt lgkmcnt(0)
    ds_read_b128 v[64:67], v134 offset:0
    ds_read_b128 v[68:71], v134 offset:32
    ds_read_b128 v[72:75], v134 offset:64
    ds_read_b128 v[76:79], v134 offset:96
    ds_read_b128 v[80:83], v134 offset:128
    ds_read_b128 v[84:87], v134 offset:160
    ds_read_b128 v[88:91], v134 offset:192
    ds_read_b128 v[92:95], v134 offset:224
    ds_read_b128 v[96:99], v134 offset:256
    ds_read_b128 v[100:103], v134 offset:288
    ds_read_b128 v[104:107], v134 offset:320
    ds_read_b128 v[108:111], v134 offset:352
    s_mov_b32 s65, 3222493025
    s_mov_b32 s66, 3184710632
    s_lshl_b32 s3, s4, 2
    s_add_u32 s3, s3, s7
    s_mul_i32 s3, s3, 86
    s_mul_i32 s60, s5, 6
    s_add_u32 s60, s60, s58
    s_lshl_b32 s67, s60, 1
    s_add_u32 s3, s3, s67
    s_lshl_b32 s61, s3, 10
    v_lshlrev_b32 v216, 4, v1
    s_waitcnt lgkmcnt(0)
    s_add_u32 s67, s60, 0
    s_cmp_ge_u32 s67, 43
    s_cbranch_scc1 k1m_skip0
    v_lshlrev_b32 v132, 16, v184
    v_and_b32 v133, 0xffff0000, v184
    v_lshlrev_b32 v134, 16, v185
    v_and_b32 v135, 0xffff0000, v185
    v_fma_f32 v132, -v12, v64, v132
    v_fma_f32 v133, -v12, v65, v133
    v_fma_f32 v134, -v12, v66, v134
    v_fma_f32 v135, -v12, v67, v135
    v_fma_f32 v132, v16, v13, v132
    v_fma_f32 v133, v17, v13, v133
    v_fma_f32 v134, v18, v13, v134
    v_fma_f32 v135, v19, v13, v135
    v_lshlrev_b32 v136, 16, v186
    v_and_b32 v137, 0xffff0000, v186
    v_lshlrev_b32 v138, 16, v187
    v_and_b32 v139, 0xffff0000, v187
    v_fma_f32 v136, -v12, v68, v136
    v_fma_f32 v137, -v12, v69, v137
    v_fma_f32 v138, -v12, v70, v138
    v_fma_f32 v139, -v12, v71, v139
    v_fma_f32 v136, v20, v13, v136
    v_fma_f32 v137, v21, v13, v137
    v_fma_f32 v138, v22, v13, v138
    v_fma_f32 v139, v23, v13, v139
    v_lshlrev_b32 v140, 16, v188
    v_and_b32 v141, 0xffff0000, v188
    v_lshlrev_b32 v142, 16, v189
    v_and_b32 v143, 0xffff0000, v189
    v_fma_f32 v140, -v12, v72, v140
    v_fma_f32 v141, -v12, v73, v141
    v_fma_f32 v142, -v12, v74, v142
    v_fma_f32 v143, -v12, v75, v143
    v_fma_f32 v140, v24, v13, v140
    v_fma_f32 v141, v25, v13, v141
    v_fma_f32 v142, v26, v13, v142
    v_fma_f32 v143, v27, v13, v143
    v_lshlrev_b32 v144, 16, v190
    v_and_b32 v145, 0xffff0000, v190
    v_lshlrev_b32 v146, 16, v191
    v_and_b32 v147, 0xffff0000, v191
    v_fma_f32 v144, -v12, v76, v144
    v_fma_f32 v145, -v12, v77, v145
    v_fma_f32 v146, -v12, v78, v146
    v_fma_f32 v147, -v12, v79, v147
    v_fma_f32 v144, v28, v13, v144
    v_fma_f32 v145, v29, v13, v145
    v_fma_f32 v146, v30, v13, v146
    v_fma_f32 v147, v31, v13, v147
    v_mul_f32 v148, v132, v132
    v_mul_f32 v149, v133, v133
    v_mul_f32 v150, v134, v134
    v_mul_f32 v151, v135, v135
    v_mul_f32 v152, v136, v136
    v_mul_f32 v153, v137, v137
    v_mul_f32 v154, v138, v138
    v_mul_f32 v155, v139, v139
    v_mul_f32 v156, v140, v140
    v_mul_f32 v157, v141, v141
    v_mul_f32 v158, v142, v142
    v_mul_f32 v159, v143, v143
    v_mul_f32 v160, v144, v144
    v_mul_f32 v161, v145, v145
    v_mul_f32 v162, v146, v146
    v_mul_f32 v163, v147, v147
    v_mov_b32 v180, s65
    v_fma_f32 v148, v148, s66, v180
    v_fma_f32 v149, v149, s66, v180
    v_fma_f32 v150, v150, s66, v180
    v_fma_f32 v151, v151, s66, v180
    v_fma_f32 v152, v152, s66, v180
    v_fma_f32 v153, v153, s66, v180
    v_fma_f32 v154, v154, s66, v180
    v_fma_f32 v155, v155, s66, v180
    v_fma_f32 v156, v156, s66, v180
    v_fma_f32 v157, v157, s66, v180
    v_fma_f32 v158, v158, s66, v180
    v_fma_f32 v159, v159, s66, v180
    v_fma_f32 v160, v160, s66, v180
    v_fma_f32 v161, v161, s66, v180
    v_fma_f32 v162, v162, s66, v180
    v_fma_f32 v163, v163, s66, v180
    v_mul_f32 v148, v148, v132
    v_mul_f32 v149, v149, v133
    v_mul_f32 v150, v150, v134
    v_mul_f32 v151, v151, v135
    v_mul_f32 v152, v152, v136
    v_mul_f32 v153, v153, v137
    v_mul_f32 v154, v154, v138
    v_mul_f32 v155, v155, v139
    v_mul_f32 v156, v156, v140
    v_mul_f32 v157, v157, v141
    v_mul_f32 v158, v158, v142
    v_mul_f32 v159, v159, v143
    v_mul_f32 v160, v160, v144
    v_mul_f32 v161, v161, v145
    v_mul_f32 v162, v162, v146
    v_mul_f32 v163, v163, v147
    v_exp_f32 v148, v148
    v_exp_f32 v149, v149
    v_exp_f32 v150, v150
    v_exp_f32 v151, v151
    v_exp_f32 v152, v152
    v_exp_f32 v153, v153
    v_exp_f32 v154, v154
    v_exp_f32 v155, v155
    v_exp_f32 v156, v156
    v_exp_f32 v157, v157
    v_exp_f32 v158, v158
    v_exp_f32 v159, v159
    v_exp_f32 v160, v160
    v_exp_f32 v161, v161
    v_exp_f32 v162, v162
    v_exp_f32 v163, v163
    v_add_f32 v148, 1.0, v148
    v_add_f32 v149, 1.0, v149
    v_add_f32 v150, 1.0, v150
    v_add_f32 v151, 1.0, v151
    v_add_f32 v152, 1.0, v152
    v_add_f32 v153, 1.0, v153
    v_add_f32 v154, 1.0, v154
    v_add_f32 v155, 1.0, v155
    v_add_f32 v156, 1.0, v156
    v_add_f32 v157, 1.0, v157
    v_add_f32 v158, 1.0, v158
    v_add_f32 v159, 1.0, v159
    v_add_f32 v160, 1.0, v160
    v_add_f32 v161, 1.0, v161
    v_add_f32 v162, 1.0, v162
    v_add_f32 v163, 1.0, v163
    v_rcp_f32 v148, v148
    v_rcp_f32 v149, v149
    v_rcp_f32 v150, v150
    v_rcp_f32 v151, v151
    v_rcp_f32 v152, v152
    v_rcp_f32 v153, v153
    v_rcp_f32 v154, v154
    v_rcp_f32 v155, v155
    v_rcp_f32 v156, v156
    v_rcp_f32 v157, v157
    v_rcp_f32 v158, v158
    v_rcp_f32 v159, v159
    v_rcp_f32 v160, v160
    v_rcp_f32 v161, v161
    v_rcp_f32 v162, v162
    v_rcp_f32 v163, v163
    v_mul_f32 v148, v148, v132
    v_mul_f32 v149, v149, v133
    v_mul_f32 v150, v150, v134
    v_mul_f32 v151, v151, v135
    v_mul_f32 v152, v152, v136
    v_mul_f32 v153, v153, v137
    v_mul_f32 v154, v154, v138
    v_mul_f32 v155, v155, v139
    v_mul_f32 v156, v156, v140
    v_mul_f32 v157, v157, v141
    v_mul_f32 v158, v158, v142
    v_mul_f32 v159, v159, v143
    v_mul_f32 v160, v160, v144
    v_mul_f32 v161, v161, v145
    v_mul_f32 v162, v162, v146
    v_mul_f32 v163, v163, v147
    v_cvt_pk_bf16_f32 v164, v148, v149
    v_cvt_pk_bf16_f32 v165, v150, v151
    v_cvt_pk_bf16_f32 v166, v152, v153
    v_cvt_pk_bf16_f32 v167, v154, v155
    v_cvt_pk_bf16_f32 v168, v156, v157
    v_cvt_pk_bf16_f32 v169, v158, v159
    v_cvt_pk_bf16_f32 v170, v160, v161
    v_cvt_pk_bf16_f32 v171, v162, v163
    buffer_store_dwordx4 v[164:167], v216, s[24:27], s61 offen sc1
    buffer_store_dwordx4 v[168:171], v216, s[24:27], s61 offen offset:1024 sc1
    s_add_u32 s61, s61, 4096
    s_branch k1m_join0
k1m_skip0:
    s_waitcnt vmcnt(0)
k1m_join0:
    s_nop 7
    s_nop 7
    s_add_u32 s67, s60, 2
    s_cmp_ge_u32 s67, 43
    s_cbranch_scc1 k1m_skip1
    v_lshlrev_b32 v132, 16, v192
    v_and_b32 v133, 0xffff0000, v192
    v_lshlrev_b32 v134, 16, v193
    v_and_b32 v135, 0xffff0000, v193
    v_fma_f32 v132, -v12, v80, v132
    v_fma_f32 v133, -v12, v81, v133
    v_fma_f32 v134, -v12, v82, v134
    v_fma_f32 v135, -v12, v83, v135
    v_fma_f32 v132, v32, v13, v132
    v_fma_f32 v133, v33, v13, v133
    v_fma_f32 v134, v34, v13, v134
    v_fma_f32 v135, v35, v13, v135
    v_lshlrev_b32 v136, 16, v194
    v_and_b32 v137, 0xffff0000, v194
    v_lshlrev_b32 v138, 16, v195
    v_and_b32 v139, 0xffff0000, v195
    v_fma_f32 v136, -v12, v84, v136
    v_fma_f32 v137, -v12, v85, v137
    v_fma_f32 v138, -v12, v86, v138
    v_fma_f32 v139, -v12, v87, v139
    v_fma_f32 v136, v36, v13, v136
    v_fma_f32 v137, v37, v13, v137
    v_fma_f32 v138, v38, v13, v138
    v_fma_f32 v139, v39, v13, v139
    v_lshlrev_b32 v140, 16, v196
    v_and_b32 v141, 0xffff0000, v196
    v_lshlrev_b32 v142, 16, v197
    v_and_b32 v143, 0xffff0000, v197
    v_fma_f32 v140, -v12, v88, v140
    v_fma_f32 v141, -v12, v89, v141
    v_fma_f32 v142, -v12, v90, v142
    v_fma_f32 v143, -v12, v91, v143
    v_fma_f32 v140, v40, v13, v140
    v_fma_f32 v141, v41, v13, v141
    v_fma_f32 v142, v42, v13, v142
    v_fma_f32 v143, v43, v13, v143
    v_lshlrev_b32 v144, 16, v198
    v_and_b32 v145, 0xffff0000, v198
    v_lshlrev_b32 v146, 16, v199
    v_and_b32 v147, 0xffff0000, v199
    v_fma_f32 v144, -v12, v92, v144
    v_fma_f32 v145, -v12, v93, v145
    v_fma_f32 v146, -v12, v94, v146
    v_fma_f32 v147, -v12, v95, v147
    v_fma_f32 v144, v44, v13, v144
    v_fma_f32 v145, v45, v13, v145
    v_fma_f32 v146, v46, v13, v146
    v_fma_f32 v147, v47, v13, v147
    v_mul_f32 v148, v132, v132
    v_mul_f32 v149, v133, v133
    v_mul_f32 v150, v134, v134
    v_mul_f32 v151, v135, v135
    v_mul_f32 v152, v136, v136
    v_mul_f32 v153, v137, v137
    v_mul_f32 v154, v138, v138
    v_mul_f32 v155, v139, v139
    v_mul_f32 v156, v140, v140
    v_mul_f32 v157, v141, v141
    v_mul_f32 v158, v142, v142
    v_mul_f32 v159, v143, v143
    v_mul_f32 v160, v144, v144
    v_mul_f32 v161, v145, v145
    v_mul_f32 v162, v146, v146
    v_mul_f32 v163, v147, v147
    v_mov_b32 v180, s65
    v_fma_f32 v148, v148, s66, v180
    v_fma_f32 v149, v149, s66, v180
    v_fma_f32 v150, v150, s66, v180
    v_fma_f32 v151, v151, s66, v180
    v_fma_f32 v152, v152, s66, v180
    v_fma_f32 v153, v153, s66, v180
    v_fma_f32 v154, v154, s66, v180
    v_fma_f32 v155, v155, s66, v180
    v_fma_f32 v156, v156, s66, v180
    v_fma_f32 v157, v157, s66, v180
    v_fma_f32 v158, v158, s66, v180
    v_fma_f32 v159, v159, s66, v180
    v_fma_f32 v160, v160, s66, v180
    v_fma_f32 v161, v161, s66, v180
    v_fma_f32 v162, v162, s66, v180
    v_fma_f32 v163, v163, s66, v180
    v_mul_f32 v148, v148, v132
    v_mul_f32 v149, v149, v133
    v_mul_f32 v150, v150, v134
    v_mul_f32 v151, v151, v135
    v_mul_f32 v152, v152, v136
    v_mul_f32 v153, v153, v137
    v_mul_f32 v154, v154, v138
    v_mul_f32 v155, v155, v139
    v_mul_f32 v156, v156, v140
    v_mul_f32 v157, v157, v141
    v_mul_f32 v158, v158, v142
    v_mul_f32 v159, v159, v143
    v_mul_f32 v160, v160, v144
    v_mul_f32 v161, v161, v145
    v_mul_f32 v162, v162, v146
    v_mul_f32 v163, v163, v147
    v_exp_f32 v148, v148
    v_exp_f32 v149, v149
    v_exp_f32 v150, v150
    v_exp_f32 v151, v151
    v_exp_f32 v152, v152
    v_exp_f32 v153, v153
    v_exp_f32 v154, v154
    v_exp_f32 v155, v155
    v_exp_f32 v156, v156
    v_exp_f32 v157, v157
    v_exp_f32 v158, v158
    v_exp_f32 v159, v159
    v_exp_f32 v160, v160
    v_exp_f32 v161, v161
    v_exp_f32 v162, v162
    v_exp_f32 v163, v163
    v_add_f32 v148, 1.0, v148
    v_add_f32 v149, 1.0, v149
    v_add_f32 v150, 1.0, v150
    v_add_f32 v151, 1.0, v151
    v_add_f32 v152, 1.0, v152
    v_add_f32 v153, 1.0, v153
    v_add_f32 v154, 1.0, v154
    v_add_f32 v155, 1.0, v155
    v_add_f32 v156, 1.0, v156
    v_add_f32 v157, 1.0, v157
    v_add_f32 v158, 1.0, v158
    v_add_f32 v159, 1.0, v159
    v_add_f32 v160, 1.0, v160
    v_add_f32 v161, 1.0, v161
    v_add_f32 v162, 1.0, v162
    v_add_f32 v163, 1.0, v163
    v_rcp_f32 v148, v148
    v_rcp_f32 v149, v149
    v_rcp_f32 v150, v150
    v_rcp_f32 v151, v151
    v_rcp_f32 v152, v152
    v_rcp_f32 v153, v153
    v_rcp_f32 v154, v154
    v_rcp_f32 v155, v155
    v_rcp_f32 v156, v156
    v_rcp_f32 v157, v157
    v_rcp_f32 v158, v158
    v_rcp_f32 v159, v159
    v_rcp_f32 v160, v160
    v_rcp_f32 v161, v161
    v_rcp_f32 v162, v162
    v_rcp_f32 v163, v163
    v_mul_f32 v148, v148, v132
    v_mul_f32 v149, v149, v133
    v_mul_f32 v150, v150, v134
    v_mul_f32 v151, v151, v135
    v_mul_f32 v152, v152, v136
    v_mul_f32 v153, v153, v137
    v_mul_f32 v154, v154, v138
    v_mul_f32 v155, v155, v139
    v_mul_f32 v156, v156, v140
    v_mul_f32 v157, v157, v141
    v_mul_f32 v158, v158, v142
    v_mul_f32 v159, v159, v143
    v_mul_f32 v160, v160, v144
    v_mul_f32 v161, v161, v145
    v_mul_f32 v162, v162, v146
    v_mul_f32 v163, v163, v147
    v_cvt_pk_bf16_f32 v172, v148, v149
    v_cvt_pk_bf16_f32 v173, v150, v151
    v_cvt_pk_bf16_f32 v174, v152, v153
    v_cvt_pk_bf16_f32 v175, v154, v155
    v_cvt_pk_bf16_f32 v176, v156, v157
    v_cvt_pk_bf16_f32 v177, v158, v159
    v_cvt_pk_bf16_f32 v178, v160, v161
    v_cvt_pk_bf16_f32 v179, v162, v163
    buffer_store_dwordx4 v[172:175], v216, s[24:27], s61 offen sc1
    buffer_store_dwordx4 v[176:179], v216, s[24:27], s61 offen offset:1024 sc1
    s_add_u32 s61, s61, 4096
    s_branch k1m_join1
k1m_skip1:
    s_waitcnt vmcnt(0)
k1m_join1:
    s_nop 7
    s_nop 7
    s_waitcnt vmcnt(2)
    s_mov_b64 exec, 1
    v_mov_b32 v252, 155664
    v_mov_b32 v253, 1
    ds_add_rtn_u32 v254, v252, v253
    s_waitcnt lgkmcnt(0)
    v_readfirstlane_b32 s3, v254
    s_nop 0
    s_cmp_lg_u32 s3, 7
    s_cbranch_scc1 sg_m0
    s_mov_b64 exec, 3
    s_mul_i32 s3, s4, 512
    s_add_u32 s3, s3, 0
    v_mul_u32_u24 v252, 256, v1
    v_mov_b32 v253, 1
    buffer_atomic_add v253, v252, s[16:19], s3 offen
sg_m0:
    s_mov_b64 exec, -1
    v_mov_b32 v246, 0
    s_add_u32 s67, s60, 4
    s_cmp_ge_u32 s67, 43
    s_cbranch_scc1 k1m_skip2
    v_lshlrev_b32 v132, 16, v200
    v_and_b32 v133, 0xffff0000, v200
    v_lshlrev_b32 v134, 16, v201
    v_and_b32 v135, 0xffff0000, v201
    v_fma_f32 v132, -v12, v96, v132
    v_fma_f32 v133, -v12, v97, v133
    v_fma_f32 v134, -v12, v98, v134
    v_fma_f32 v135, -v12, v99, v135
    v_fma_f32 v132, v48, v13, v132
    v_fma_f32 v133, v49, v13, v133
    v_fma_f32 v134, v50, v13, v134
    v_fma_f32 v135, v51, v13, v135
    v_lshlrev_b32 v136, 16, v202
    v_and_b32 v137, 0xffff0000, v202
    v_lshlrev_b32 v138, 16, v203
    v_and_b32 v139, 0xffff0000, v203
    v_fma_f32 v136, -v12, v100, v136
    v_fma_f32 v137, -v12, v101, v137
    v_fma_f32 v138, -v12, v102, v138
    v_fma_f32 v139, -v12, v103, v139
    v_fma_f32 v136, v52, v13, v136
    v_fma_f32 v137, v53, v13, v137
    v_fma_f32 v138, v54, v13, v138
    v_fma_f32 v139, v55, v13, v139
    v_lshlrev_b32 v140, 16, v204
    v_and_b32 v141, 0xffff0000, v204
    v_lshlrev_b32 v142, 16, v205
    v_and_b32 v143, 0xffff0000, v205
    v_fma_f32 v140, -v12, v104, v140
    v_fma_f32 v141, -v12, v105, v141
    v_fma_f32 v142, -v12, v106, v142
    v_fma_f32 v143, -v12, v107, v143
    v_fma_f32 v140, v56, v13, v140
    v_fma_f32 v141, v57, v13, v141
    v_fma_f32 v142, v58, v13, v142
    v_fma_f32 v143, v59, v13, v143
    v_lshlrev_b32 v144, 16, v206
    v_and_b32 v145, 0xffff0000, v206
    v_lshlrev_b32 v146, 16, v207
    v_and_b32 v147, 0xffff0000, v207
    v_fma_f32 v144, -v12, v108, v144
    v_fma_f32 v145, -v12, v109, v145
    v_fma_f32 v146, -v12, v110, v146
    v_fma_f32 v147, -v12, v111, v147
    v_fma_f32 v144, v60, v13, v144
    v_fma_f32 v145, v61, v13, v145
    v_fma_f32 v146, v62, v13, v146
    v_fma_f32 v147, v63, v13, v147
    v_mul_f32 v148, v132, v132
    v_mul_f32 v149, v133, v133
    v_mul_f32 v150, v134, v134
    v_mul_f32 v151, v135, v135
    v_mul_f32 v152, v136, v136
    v_mul_f32 v153, v137, v137
    v_mul_f32 v154, v138, v138
    v_mul_f32 v155, v139, v139
    v_mul_f32 v156, v140, v140
    v_mul_f32 v157, v141, v141
    v_mul_f32 v158, v142, v142
    v_mul_f32 v159, v143, v143
    v_mul_f32 v160, v144, v144
    v_mul_f32 v161, v145, v145
    v_mul_f32 v162, v146, v146
    v_mul_f32 v163, v147, v147
    v_mov_b32 v180, s65
    v_fma_f32 v148, v148, s66, v180
    v_fma_f32 v149, v149, s66, v180
    v_fma_f32 v150, v150, s66, v180
    v_fma_f32 v151, v151, s66, v180
    v_fma_f32 v152, v152, s66, v180
    v_fma_f32 v153, v153, s66, v180
    v_fma_f32 v154, v154, s66, v180
    v_fma_f32 v155, v155, s66, v180
    v_fma_f32 v156, v156, s66, v180
    v_fma_f32 v157, v157, s66, v180
    v_fma_f32 v158, v158, s66, v180
    v_fma_f32 v159, v159, s66, v180
    v_fma_f32 v160, v160, s66, v180
    v_fma_f32 v161, v161, s66, v180
    v_fma_f32 v162, v162, s66, v180
    v_fma_f32 v163, v163, s66, v180
    v_mul_f32 v148, v148, v132
    v_mul_f32 v149, v149, v133
    v_mul_f32 v150, v150, v134
    v_mul_f32 v151, v151, v135
    v_mul_f32 v152, v152, v136
    v_mul_f32 v153, v153, v137
    v_mul_f32 v154, v154, v138
    v_mul_f32 v155, v155, v139
    v_mul_f32 v156, v156, v140
    v_mul_f32 v157, v157, v141
    v_mul_f32 v158, v158, v142
    v_mul_f32 v159, v159, v143
    v_mul_f32 v160, v160, v144
    v_mul_f32 v161, v161, v145
    v_mul_f32 v162, v162, v146
    v_mul_f32 v163, v163, v147
    v_exp_f32 v148, v148
    v_exp_f32 v149, v149
    v_exp_f32 v150, v150
    v_exp_f32 v151, v151
    v_exp_f32 v152, v152
    v_exp_f32 v153, v153
    v_exp_f32 v154, v154
    v_exp_f32 v155, v155
    v_exp_f32 v156, v156
    v_exp_f32 v157, v157
    v_exp_f32 v158, v158
    v_exp_f32 v159, v159
    v_exp_f32 v160, v160
    v_exp_f32 v161, v161
    v_exp_f32 v162, v162
    v_exp_f32 v163, v163
    v_add_f32 v148, 1.0, v148
    v_add_f32 v149, 1.0, v149
    v_add_f32 v150, 1.0, v150
    v_add_f32 v151, 1.0, v151
    v_add_f32 v152, 1.0, v152
    v_add_f32 v153, 1.0, v153
    v_add_f32 v154, 1.0, v154
    v_add_f32 v155, 1.0, v155
    v_add_f32 v156, 1.0, v156
    v_add_f32 v157, 1.0, v157
    v_add_f32 v158, 1.0, v158
    v_add_f32 v159, 1.0, v159
    v_add_f32 v160, 1.0, v160
    v_add_f32 v161, 1.0, v161
    v_add_f32 v162, 1.0, v162
    v_add_f32 v163, 1.0, v163
    v_rcp_f32 v148, v148
    v_rcp_f32 v149, v149
    v_rcp_f32 v150, v150
    v_rcp_f32 v151, v151
    v_rcp_f32 v152, v152
    v_rcp_f32 v153, v153
    v_rcp_f32 v154, v154
    v_rcp_f32 v155, v155
    v_rcp_f32 v156, v156
    v_rcp_f32 v157, v157
    v_rcp_f32 v158, v158
    v_rcp_f32 v159, v159
    v_rcp_f32 v160, v160
    v_rcp_f32 v161, v161
    v_rcp_f32 v162, v162
    v_rcp_f32 v163, v163
    v_mul_f32 v148, v148, v132
    v_mul_f32 v149, v149, v133
    v_mul_f32 v150, v150, v134
    v_mul_f32 v151, v151, v135
    v_mul_f32 v152, v152, v136
    v_mul_f32 v153, v153, v137
    v_mul_f32 v154, v154, v138
    v_mul_f32 v155, v155, v139
    v_mul_f32 v156, v156, v140
    v_mul_f32 v157, v157, v141
    v_mul_f32 v158, v158, v142
    v_mul_f32 v159, v159, v143
    v_mul_f32 v160, v160, v144
    v_mul_f32 v161, v161, v145
    v_mul_f32 v162, v162, v146
    v_mul_f32 v163, v163, v147
    v_cvt_pk_bf16_f32 v164, v148, v149
    v_cvt_pk_bf16_f32 v165, v150, v151
    v_cvt_pk_bf16_f32 v166, v152, v153
    v_cvt_pk_bf16_f32 v167, v154, v155
    v_cvt_pk_bf16_f32 v168, v156, v157
    v_cvt_pk_bf16_f32 v169, v158, v159
    v_cvt_pk_bf16_f32 v170, v160, v161
    v_cvt_pk_bf16_f32 v171, v162, v163
    buffer_store_dwordx4 v[164:167], v216, s[24:27], s61 offen sc1
    buffer_store_dwordx4 v[168:171], v216, s[24:27], s61 offen offset:1024 sc1
    s_add_u32 s61, s61, 4096
    s_branch k1m_join2
k1m_skip2:
    s_waitcnt vmcnt(0)
k1m_join2:
    s_nop 7
    s_nop 7
    s_waitcnt vmcnt(2)
    s_mov_b64 exec, 1
    v_mov_b32 v252, 155668
    v_mov_b32 v253, 1
    ds_add_rtn_u32 v254, v252, v253
    s_waitcnt lgkmcnt(0)
    v_readfirstlane_b32 s3, v254
    s_nop 0
    s_cmp_lg_u32 s3, 7
    s_cbranch_scc1 sg_m1
    s_mov_b64 exec, 3
    s_mul_i32 s3, s4, 512
    s_add_u32 s3, s3, 4
    v_mul_u32_u24 v252, 256, v1
    v_mov_b32 v253, 1
    buffer_atomic_add v253, v252, s[16:19], s3 offen
sg_m1:
    s_mov_b64 exec, -1
    s_cmp_lg_u32 s6, 5
    s_cbranch_scc1 mt_m
    s_mov_b32 s60, 0
    s_mov_b64 exec, 0x1f
    s_waitcnt vmcnt(0)
    s_mov_b64 exec, 1
    v_mov_b32 v252, 155672
    v_mov_b32 v253, 1
    ds_add_rtn_u32 v254, v252, v253
    s_waitcnt lgkmcnt(0)
    v_readfirstlane_b32 s3, v254
    s_nop 0
    s_cmp_lg_u32 s3, 7
    s_cbranch_scc1 sg_m2w5
    s_mov_b64 exec, 3
    s_mul_i32 s3, s4, 512
    s_add_u32 s3, s3, 8
    v_mul_u32_u24 v252, 256, v1
    v_mov_b32 v253, 1
    buffer_atomic_add v253, v252, s[16:19], s3 offen
sg_m2w5:
    s_mov_b64 exec, -1
    s_mov_b64 exec, 0x1f
    v_mov_b32 v246, 0
    buffer_atomic_add v246, v244, s[16:19], 0 offen sc0
    s_branch helper
mt_m:
    s_waitcnt vmcnt(0)
    s_mov_b64 exec, 1
    v_mov_b32 v252, 155672
    v_mov_b32 v253, 1
    ds_add_rtn_u32 v254, v252, v253
    s_waitcnt lgkmcnt(0)
    v_readfirstlane_b32 s3, v254
    s_nop 0
    s_cmp_lg_u32 s3, 7
    s_cbranch_scc1 sg_m2
    s_mov_b64 exec, 3
    s_mul_i32 s3, s4, 512
    s_add_u32 s3, s3, 8
    v_mul_u32_u24 v252, 256, v1
    v_mov_b32 v253, 1
    buffer_atomic_add v253, v252, s[16:19], s3 offen
sg_m2:
    s_mov_b64 exec, -1
    s_cmp_lt_u32 s6, 4
    s_cbranch_scc1 phase2
    s_endpgm
phase2:
    s_nop 7
    s_nop 7
    s_and_b32 s3, s2, 7
    s_lshr_b32 s59, s2, 3
    s_lshl_b32 s4, s3, 2
    s_lshr_b32 s5, s59, 3
    s_add_u32 s4, s4, s5
    s_and_b32 s5, s59, 7
    s_mov_b32 s12, s38
    s_mov_b32 s13, s39
    s_mov_b32 s14, 524288
    s_mov_b32 s15, 0x00020000
    s_mov_b32 s16, s56
    s_mov_b32 s17, s57
    s_mov_b32 s18, 5636096
    s_mov_b32 s19, 0x00020000
    s_add_u32 s20, s56, 6291456
    s_addc_u32 s21, s57, 0
    s_mov_b32 s22, 4194304
    s_mov_b32 s23, 0x00020000
    s_add_u32 s24, s56, 10485760
    s_addc_u32 s25, s57, 0
    s_mov_b32 s26, 2097152
    s_mov_b32 s27, 0x00020000
    s_add_u32 s28, s56, 12648448
    s_addc_u32 s29, s57, 0
    s_mov_b32 s30, 8192
    s_mov_b32 s31, 0x00020000
    s_mov_b32 s60, s48
    s_mov_b32 s61, s49
    s_mov_b32 s62, 1024
    s_mov_b32 s63, 0x00020000
    s_mov_b32 s64, s52
    s_mov_b32 s65, s53
    s_mov_b32 s66, 2097152
    s_mov_b32 s67, 0x00020000
    v_and_b32 v7, 31, v1
    v_lshrrev_b32 v15, 5, v1
    s_lshr_b32 s3, s6, 1
    s_lshl_b32 s3, s3, 6
    s_lshl_b32 s59, s5, 7
    s_add_u32 s3, s3, s59
    v_lshlrev_b32 v2, 3, v15
    v_add_u32 v2, s3, v2
    buffer_load_dwordx2 v[240:241], v2, s[60:63], 0 offen offset:0
    buffer_load_dwordx2 v[242:243], v2, s[60:63], 0 offen offset:16
    buffer_load_dwordx2 v[244:245], v2, s[60:63], 0 offen offset:32
    buffer_load_dwordx2 v[246:247], v2, s[60:63], 0 offen offset:48
    v_mov_b32 v251, 155648
    v_lshlrev_b32 v3, 4, v1
    v_lshlrev_b32 v4, 9, v15
    v_bfe_u32 v6, v1, 2, 2
    v_lshl_add_u32 v4, v6, 6, v4
    v_bfe_u32 v6, v1, 4, 1
    v_lshl_add_u32 v4, v6, 5, v4
    v_and_b32 v6, 3, v1
    v_lshl_add_u32 v4, v6, 3, v4
    v_add_u32 v4, s68, v4
    v_add_u32 v4, 0x8000, v4
    v_add_u32 v5, 0x10000, v4
    s_lshl_b32 s69, s4, 1
    s_mul_i32 s70, s69, 86
    s_cmp_lt_u32 s6, 2
    s_cselect_b32 s3, 8, 0
    s_sub_u32 s3, s6, s3
    s_sub_u32 s41, s3, 82
    s_sub_u32 s42, s3, 162
    s_mov_b32 s40, s6
    s_cmp_lt_u32 s6, 2
    s_cselect_b32 s43, s40, s41
    s_cselect_b32 s44, s41, s42
    s_sub_u32 s3, s42, 12
    s_cmp_lt_u32 s6, 2
    s_cselect_b32 s45, s42, s3
    s_add_u32 s40, s40, s70
    s_lshl_b32 s40, s40, 10
    s_add_u32 s41, s41, s70
    s_lshl_b32 s41, s41, 10
    s_add_u32 s42, s42, s70
    s_lshl_b32 s42, s42, 10
    s_add_u32 s43, s43, s70
    s_lshl_b32 s43, s43, 10
    s_add_u32 s44, s44, s70
    s_lshl_b32 s44, s44, 10
    s_add_u32 s45, s45, s70
    s_lshl_b32 s45, s45, 10
    s_mov_b32 s3, s69
    s_lshl_b32 s72, s3, 5
    s_lshl_b32 s59, s6, 3
    s_add_u32 s72, s72, s59
    s_lshl_b32 s72, s72, 10
    s_lshl_b32 s75, s6, 17
    s_lshl_b32 s3, s4, 6
    v_add_u32 v2, s3, v7
    v_lshlrev_b32 v2, 2, v2
    s_waitcnt vmcnt(4)
    ds_read_b64_tr_b16 v[160:161], v4 offset:32768
    ds_read_b64_tr_b16 v[162:163], v4 offset:33792
    ds_read_b64_tr_b16 v[164:165], v4 offset:33024
    ds_read_b64_tr_b16 v[166:167], v4 offset:34048
    ds_read_b64_tr_b16 v[168:169], v4 offset:40960
    ds_read_b64_tr_b16 v[170:171], v4 offset:41984
    ds_read_b64_tr_b16 v[172:173], v4 offset:41216
    ds_read_b64_tr_b16 v[174:175], v4 offset:42240
    ds_read_b64_tr_b16 v[176:177], v4 offset:49152
    ds_read_b64_tr_b16 v[178:179], v4 offset:50176
    ds_read_b64_tr_b16 v[180:181], v4 offset:49408
    ds_read_b64_tr_b16 v[182:183], v4 offset:50432
    ds_read_b64_tr_b16 v[184:185], v4 offset:57344
    ds_read_b64_tr_b16 v[186:187], v4 offset:58368
    ds_read_b64_tr_b16 v[188:189], v4 offset:57600
    ds_read_b64_tr_b16 v[190:191], v4 offset:58624
    ds_read_b64_tr_b16 v[192:193], v5 offset:0
    ds_read_b64_tr_b16 v[194:195], v5 offset:1024
    ds_read_b64_tr_b16 v[196:197], v5 offset:256
    ds_read_b64_tr_b16 v[198:199], v5 offset:1280
    ds_read_b64_tr_b16 v[200:201], v5 offset:8192
    ds_read_b64_tr_b16 v[202:203], v5 offset:9216
    ds_read_b64_tr_b16 v[204:205], v5 offset:8448
    ds_read_b64_tr_b16 v[206:207], v5 offset:9472
    ds_read_b64_tr_b16 v[208:209], v5 offset:16384
    ds_read_b64_tr_b16 v[210:211], v5 offset:17408
    ds_read_b64_tr_b16 v[212:213], v5 offset:16640
    ds_read_b64_tr_b16 v[214:215], v5 offset:17664
    ds_read_b64_tr_b16 v[216:217], v5 offset:24576
    ds_read_b64_tr_b16 v[218:219], v5 offset:25600
    ds_read_b64_tr_b16 v[220:221], v5 offset:24832
    ds_read_b64_tr_b16 v[222:223], v5 offset:25856
    s_add_u32 s76, s33, 2162688
    s_add_u32 m0, s68, 32768
    s_nop 0
    buffer_load_dwordx4 v250, s[8:11], s76 offen lds
    s_add_u32 s76, s76, 8192
    s_add_u32 m0, s68, 33792
    s_nop 0
    buffer_load_dwordx4 v250, s[8:11], s76 offen lds
    s_add_u32 s76, s33, 2359296
    s_add_u32 m0, s68, 40960
    s_nop 0
    buffer_load_dwordx4 v250, s[8:11], s76 offen lds
    s_add_u32 s76, s76, 8192
    s_add_u32 m0, s68, 41984
    s_nop 0
    buffer_load_dwordx4 v250, s[8:11], s76 offen lds
    s_add_u32 s76, s33, 2555904
    s_add_u32 m0, s68, 49152
    s_nop 0
    buffer_load_dwordx4 v250, s[8:11], s76 offen lds
    s_add_u32 s76, s76, 8192
    s_add_u32 m0, s68, 50176
    s_nop 0
    buffer_load_dwordx4 v250, s[8:11], s76 offen lds
    s_add_u32 s76, s36, 2752512
    s_add_u32 m0, s68, 57344
    s_nop 0
    buffer_load_dwordx4 v250, s[8:11], s76 offen lds
    s_add_u32 s76, s76, 8192
    s_add_u32 m0, s68, 58368
    s_nop 0
    buffer_load_dwordx4 v250, s[8:11], s76 offen lds
    s_waitcnt lgkmcnt(0)
    s_add_u32 s76, s34, 2949120
    s_add_u32 m0, s68, 65536
    s_nop 0
    buffer_load_dwordx4 v250, s[8:11], s76 offen lds
    s_add_u32 s76, s76, 8192
    s_add_u32 m0, s68, 66560
    s_nop 0
    buffer_load_dwordx4 v250, s[8:11], s76 offen lds
    s_add_u32 s76, s34, 3145728
    s_add_u32 m0, s68, 73728
    s_nop 0
    buffer_load_dwordx4 v250, s[8:11], s76 offen lds
    s_add_u32 s76, s76, 8192
    s_add_u32 m0, s68, 74752
    s_nop 0
    buffer_load_dwordx4 v250, s[8:11], s76 offen lds
    s_add_u32 s76, s34, 3342336
    s_add_u32 m0, s68, 81920
    s_nop 0
    buffer_load_dwordx4 v250, s[8:11], s76 offen lds
    s_add_u32 s76, s76, 8192
    s_add_u32 m0, s68, 82944
    s_nop 0
    buffer_load_dwordx4 v250, s[8:11], s76 offen lds
    s_add_u32 s76, s34, 3538944
    s_add_u32 m0, s68, 90112
    s_nop 0
    buffer_load_dwordx4 v250, s[8:11], s76 offen lds
    s_add_u32 s76, s76, 8192
    s_add_u32 m0, s68, 91136
    s_nop 0
    buffer_load_dwordx4 v250, s[8:11], s76 offen lds
    s_add_u32 s76, s34, 3735552
    s_add_u32 m0, s68, 98304
    s_nop 0
    buffer_load_dwordx4 v250, s[8:11], s76 offen lds
    s_add_u32 s76, s76, 8192
    s_add_u32 m0, s68, 99328
    s_nop 0
    buffer_load_dwordx4 v250, s[8:11], s76 offen lds
    s_add_u32 s76, s34, 3932160
    s_add_u32 m0, s68, 106496
    s_nop 0
    buffer_load_dwordx4 v250, s[8:11], s76 offen lds
    s_add_u32 s76, s76, 8192
    s_add_u32 m0, s68, 107520
    s_nop 0
    buffer_load_dwordx4 v250, s[8:11], s76 offen lds
    s_add_u32 s76, s34, 4128768
    s_add_u32 m0, s68, 114688
    s_nop 0
    buffer_load_dwordx4 v250, s[8:11], s76 offen lds
    s_add_u32 s76, s76, 8192
    s_add_u32 m0, s68, 115712
    s_nop 0
    buffer_load_dwordx4 v250, s[8:11], s76 offen lds
    s_add_u32 s76, s75, 0
    s_add_u32 m0, s68, 122880
    s_nop 0
    buffer_load_dwordx4 v250, s[12:15], s76 offen lds
    s_add_u32 s76, s76, 8192
    s_add_u32 m0, s68, 123904
    s_nop 0
    buffer_load_dwordx4 v250, s[12:15], s76 offen lds
    s_mov_b32 s79, 0
lw_h0:
    ds_read_b32 v6, v251 offset:0
    s_waitcnt lgkmcnt(0)
    v_readfirstlane_b32 s78, v6
    s_nop 0
    s_cmp_lg_u32 s78, 0
    s_cbranch_scc1 ld_h0
    s_add_u32 s79, s79, 1
    s_cmp_lt_u32 s79, 524288
    s_cbranch_scc0 ld_h0
    s_sleep 1
    s_branch lw_h0
ld_h0:
    s_bitcmp1_b32 s2, 0
    s_cbranch_scc1 op_d
    s_mov_b32 s79, 0
op_w:
    ds_read_b32 v6, v251 offset:32
    s_waitcnt lgkmcnt(0)
    v_readfirstlane_b32 s78, v6
    s_nop 0
    s_cmp_ge_u32 s78, 2
    s_cbranch_scc1 op_d
    s_add_u32 s79, s79, 1
    s_cmp_lt_u32 s79, 524288
    s_cbranch_scc0 op_d
    s_sleep 1
    s_branch op_w
op_d:
    buffer_load_dword v10, v2, s[28:31], 0 offen sc1
    buffer_load_dword v11, v2, s[28:31], 0 offen offset:128 sc1
    s_add_u32 s76, s40, 0
    s_add_u32 s77, s76, 88064
    buffer_load_dwordx4 v[80:83], v3, s[16:19], s76 offen sc1
    buffer_load_dwordx4 v[84:87], v3, s[16:19], s77 offen sc1
    s_add_u32 s76, s40, 12288
    s_add_u32 s77, s76, 88064
    buffer_load_dwordx4 v[88:91], v3, s[16:19], s76 offen sc1
    buffer_load_dwordx4 v[92:95], v3, s[16:19], s77 offen sc1
    s_add_u32 s76, s40, 24576
    s_add_u32 s77, s76, 88064
    buffer_load_dwordx4 v[96:99], v3, s[16:19], s76 offen sc1
    buffer_load_dwordx4 v[100:103], v3, s[16:19], s77 offen sc1
    s_add_u32 s76, s40, 36864
    s_add_u32 s77, s76, 88064
    buffer_load_dwordx4 v[104:107], v3, s[16:19], s76 offen sc1
    buffer_load_dwordx4 v[108:111], v3, s[16:19], s77 offen sc1
    s_add_u32 s76, s40, 49152
    s_add_u32 s77, s76, 88064
    buffer_load_dwordx4 v[112:115], v3, s[16:19], s76 offen sc1
    buffer_load_dwordx4 v[116:119], v3, s[16:19], s77 offen sc1
    s_add_u32 s76, s40, 61440
    s_add_u32 s77, s76, 88064
    buffer_load_dwordx4 v[120:123], v3, s[16:19], s76 offen sc1
    buffer_load_dwordx4 v[124:127], v3, s[16:19], s77 offen sc1
    s_add_u32 s76, s40, 73728
    s_add_u32 s77, s76, 88064
    buffer_load_dwordx4 v[128:131], v3, s[16:19], s76 offen sc1
    buffer_load_dwordx4 v[132:135], v3, s[16:19], s77 offen sc1
    s_waitcnt vmcnt(12)
    s_waitcnt vmcnt(10)
    v_mfma_f32_32x32x16_bf16 v[16:31], v[160:163], v[80:83], 0
    v_mfma_f32_32x32x16_bf16 v[32:47], v[160:163], v[84:87], 0
    v_mfma_f32_32x32x16_bf16 v[48:63], v[164:167], v[80:83], 0
    v_mfma_f32_32x32x16_bf16 v[64:79], v[164:167], v[84:87], 0
    s_waitcnt vmcnt(8)
    v_mfma_f32_32x32x16_bf16 v[16:31], v[168:171], v[88:91], v[16:31]
    v_mfma_f32_32x32x16_bf16 v[32:47], v[168:171], v[92:95], v[32:47]
    v_mfma_f32_32x32x16_bf16 v[48:63], v[172:175], v[88:91], v[48:63]
    v_mfma_f32_32x32x16_bf16 v[64:79], v[172:175], v[92:95], v[64:79]
    s_waitcnt vmcnt(6)
    v_mfma_f32_32x32x16_bf16 v[16:31], v[176:179], v[96:99], v[16:31]
    v_mfma_f32_32x32x16_bf16 v[32:47], v[176:179], v[100:103], v[32:47]
    v_mfma_f32_32x32x16_bf16 v[48:63], v[180:183], v[96:99], v[48:63]
    v_mfma_f32_32x32x16_bf16 v[64:79], v[180:183], v[100:103], v[64:79]
    s_waitcnt vmcnt(4)
    v_mfma_f32_32x32x16_bf16 v[16:31], v[184:187], v[104:107], v[16:31]
    v_mfma_f32_32x32x16_bf16 v[32:47], v[184:187], v[108:111], v[32:47]
    v_mfma_f32_32x32x16_bf16 v[48:63], v[188:191], v[104:107], v[48:63]
    v_mfma_f32_32x32x16_bf16 v[64:79], v[188:191], v[108:111], v[64:79]
    s_waitcnt vmcnt(2)
    v_mfma_f32_32x32x16_bf16 v[16:31], v[192:195], v[112:115], v[16:31]
    v_mfma_f32_32x32x16_bf16 v[32:47], v[192:195], v[116:119], v[32:47]
    v_mfma_f32_32x32x16_bf16 v[48:63], v[196:199], v[112:115], v[48:63]
    v_mfma_f32_32x32x16_bf16 v[64:79], v[196:199], v[116:119], v[64:79]
    s_mov_b32 s79, 0
lw_h1:
    ds_read_b32 v249, v251 offset:4
    s_waitcnt lgkmcnt(0)
    v_readfirstlane_b32 s78, v249
    s_nop 0
    s_cmp_lg_u32 s78, 0
    s_cbranch_scc1 ld_h1
    s_add_u32 s79, s79, 1
    s_cmp_lt_u32 s79, 524288
    s_cbranch_scc0 ld_h1
    s_sleep 1
    s_branch lw_h1
ld_h1:
    s_add_u32 s76, s43, 86016
    s_add_u32 s77, s76, 88064
    buffer_load_dwordx4 v[136:139], v3, s[16:19], s76 offen sc1
    buffer_load_dwordx4 v[140:143], v3, s[16:19], s77 offen sc1
    s_add_u32 s76, s41, 98304
    s_add_u32 s77, s76, 88064
    buffer_load_dwordx4 v[80:83], v3, s[16:19], s76 offen sc1
    buffer_load_dwordx4 v[84:87], v3, s[16:19], s77 offen sc1
    s_waitcnt vmcnt(4)
    v_mfma_f32_32x32x16_bf16 v[16:31], v[200:203], v[120:123], v[16:31]
    v_mfma_f32_32x32x16_bf16 v[32:47], v[200:203], v[124:127], v[32:47]
    v_mfma_f32_32x32x16_bf16 v[48:63], v[204:207], v[120:123], v[48:63]
    v_mfma_f32_32x32x16_bf16 v[64:79], v[204:207], v[124:127], v[64:79]
    s_add_u32 s76, s41, 110592
    s_add_u32 s77, s76, 88064
    buffer_load_dwordx4 v[88:91], v3, s[16:19], s76 offen sc1
    buffer_load_dwordx4 v[92:95], v3, s[16:19], s77 offen sc1
    s_add_u32 s76, s41, 122880
    s_add_u32 s77, s76, 88064
    buffer_load_dwordx4 v[96:99], v3, s[16:19], s76 offen sc1
    buffer_load_dwordx4 v[100:103], v3, s[16:19], s77 offen sc1
    s_waitcnt vmcnt(6)
    v_mfma_f32_32x32x16_bf16 v[16:31], v[208:211], v[128:131], v[16:31]
    v_mfma_f32_32x32x16_bf16 v[32:47], v[208:211], v[132:135], v[32:47]
    v_mfma_f32_32x32x16_bf16 v[48:63], v[212:215], v[128:131], v[48:63]
    v_mfma_f32_32x32x16_bf16 v[64:79], v[212:215], v[132:135], v[64:79]
    s_add_u32 s76, s41, 135168
    s_add_u32 s77, s76, 88064
    buffer_load_dwordx4 v[104:107], v3, s[16:19], s76 offen sc1
    buffer_load_dwordx4 v[108:111], v3, s[16:19], s77 offen sc1
    s_add_u32 s76, s41, 147456
    s_add_u32 s77, s76, 88064
    buffer_load_dwordx4 v[112:115], v3, s[16:19], s76 offen sc1
    buffer_load_dwordx4 v[116:119], v3, s[16:19], s77 offen sc1
    s_waitcnt vmcnt(8)
    ds_read_b64_tr_b16 v[144:145], v5 offset:32768
    ds_read_b64_tr_b16 v[146:147], v5 offset:33792
    ds_read_b64_tr_b16 v[148:149], v5 offset:33024
    ds_read_b64_tr_b16 v[150:151], v5 offset:34048
    s_waitcnt lgkmcnt(4)
    v_mfma_f32_32x32x16_bf16 v[16:31], v[216:219], v[136:139], v[16:31]
    v_mfma_f32_32x32x16_bf16 v[32:47], v[216:219], v[140:143], v[32:47]
    v_mfma_f32_32x32x16_bf16 v[48:63], v[220:223], v[136:139], v[48:63]
    v_mfma_f32_32x32x16_bf16 v[64:79], v[220:223], v[140:143], v[64:79]
    s_add_u32 s76, s41, 159744
    s_add_u32 s77, s76, 88064
    buffer_load_dwordx4 v[120:123], v3, s[16:19], s76 offen sc1
    buffer_load_dwordx4 v[124:127], v3, s[16:19], s77 offen sc1
    s_waitcnt vmcnt(8)
    ds_read_b64_tr_b16 v[152:153], v5 offset:40960
    ds_read_b64_tr_b16 v[154:155], v5 offset:41984
    ds_read_b64_tr_b16 v[156:157], v5 offset:41216
    ds_read_b64_tr_b16 v[158:159], v5 offset:42240
    s_waitcnt lgkmcnt(4)
    v_mfma_f32_32x32x16_bf16 v[16:31], v[144:147], v[80:83], v[16:31]
    v_mfma_f32_32x32x16_bf16 v[32:47], v[144:147], v[84:87], v[32:47]
    v_mfma_f32_32x32x16_bf16 v[48:63], v[148:151], v[80:83], v[48:63]
    v_mfma_f32_32x32x16_bf16 v[64:79], v[148:151], v[84:87], v[64:79]
    s_add_u32 s76, s75, 16384
    s_add_u32 m0, s68, 131072
    s_nop 0
    buffer_load_dwordx4 v250, s[12:15], s76 offen lds
    s_add_u32 s76, s76, 8192
    s_add_u32 m0, s68, 132096
    s_nop 0
    buffer_load_dwordx4 v250, s[12:15], s76 offen lds
    s_waitcnt vmcnt(8)
    ds_read_b64_tr_b16 v[144:145], v5 offset:49152
    ds_read_b64_tr_b16 v[146:147], v5 offset:50176
    ds_read_b64_tr_b16 v[148:149], v5 offset:49408
    ds_read_b64_tr_b16 v[150:151], v5 offset:50432
    s_waitcnt lgkmcnt(4)
    v_mfma_f32_32x32x16_bf16 v[16:31], v[152:155], v[88:91], v[16:31]
    v_mfma_f32_32x32x16_bf16 v[32:47], v[152:155], v[92:95], v[32:47]
    v_mfma_f32_32x32x16_bf16 v[48:63], v[156:159], v[88:91], v[48:63]
    v_mfma_f32_32x32x16_bf16 v[64:79], v[156:159], v[92:95], v[64:79]
    s_add_u32 s76, s75, 32768
    s_add_u32 m0, s68, 139264
    s_nop 0
    buffer_load_dwordx4 v250, s[12:15], s76 offen lds
    s_add_u32 s76, s76, 8192
    s_add_u32 m0, s68, 140288
    s_nop 0
    buffer_load_dwordx4 v250, s[12:15], s76 offen lds
    s_waitcnt vmcnt(8)
    ds_read_b64_tr_b16 v[152:153], v4 offset:0
    ds_read_b64_tr_b16 v[154:155], v4 offset:1024
    ds_read_b64_tr_b16 v[156:157], v4 offset:256
    ds_read_b64_tr_b16 v[158:159], v4 offset:1280
    s_waitcnt lgkmcnt(4)
    v_mfma_f32_32x32x16_bf16 v[16:31], v[144:147], v[96:99], v[16:31]
    v_mfma_f32_32x32x16_bf16 v[32:47], v[144:147], v[100:103], v[32:47]
    v_mfma_f32_32x32x16_bf16 v[48:63], v[148:151], v[96:99], v[48:63]
    v_mfma_f32_32x32x16_bf16 v[64:79], v[148:151], v[100:103], v[64:79]
    s_add_u32 s76, s75, 49152
    s_add_u32 m0, s68, 147456
    s_nop 0
    buffer_load_dwordx4 v250, s[12:15], s76 offen lds
    s_add_u32 s76, s76, 8192
    s_add_u32 m0, s68, 148480
    s_nop 0
    buffer_load_dwordx4 v250, s[12:15], s76 offen lds
    s_waitcnt vmcnt(8)
    ds_read_b64_tr_b16 v[144:145], v4 offset:8192
    ds_read_b64_tr_b16 v[146:147], v4 offset:9216
    ds_read_b64_tr_b16 v[148:149], v4 offset:8448
    ds_read_b64_tr_b16 v[150:151], v4 offset:9472
    s_waitcnt lgkmcnt(4)
    v_mfma_f32_32x32x16_bf16 v[16:31], v[152:155], v[104:107], v[16:31]
    v_mfma_f32_32x32x16_bf16 v[32:47], v[152:155], v[108:111], v[32:47]
    v_mfma_f32_32x32x16_bf16 v[48:63], v[156:159], v[104:107], v[48:63]
    v_mfma_f32_32x32x16_bf16 v[64:79], v[156:159], v[108:111], v[64:79]
    s_mov_b32 s79, 0
lw_h2:
    ds_read_b32 v249, v251 offset:8
    s_waitcnt lgkmcnt(0)
    v_readfirstlane_b32 s78, v249
    s_nop 0
    s_cmp_lg_u32 s78, 0
    s_cbranch_scc1 ld_h2
    s_add_u32 s79, s79, 1
    s_cmp_lt_u32 s79, 524288
    s_cbranch_scc0 ld_h2
    s_sleep 1
    s_branch lw_h2
ld_h2:
    s_add_u32 s76, s44, 172032
    s_add_u32 s77, s76, 88064
    buffer_load_dwordx4 v[128:131], v3, s[16:19], s76 offen sc1
    buffer_load_dwordx4 v[132:135], v3, s[16:19], s77 offen sc1
    s_add_u32 s76, s42, 184320
    s_add_u32 s77, s76, 88064
    buffer_load_dwordx4 v[136:139], v3, s[16:19], s76 offen sc1
    buffer_load_dwordx4 v[140:143], v3, s[16:19], s77 offen sc1
    s_add_u32 s76, s75, 65536
    s_add_u32 m0, s68, 32768
    s_nop 0
    buffer_load_dwordx4 v250, s[12:15], s76 offen lds
    s_add_u32 s76, s76, 8192
    s_add_u32 m0, s68, 33792
    s_nop 0
    buffer_load_dwordx4 v250, s[12:15], s76 offen lds
    s_waitcnt vmcnt(12)
    ds_read_b64_tr_b16 v[152:153], v4 offset:16384
    ds_read_b64_tr_b16 v[154:155], v4 offset:17408
    ds_read_b64_tr_b16 v[156:157], v4 offset:16640
    ds_read_b64_tr_b16 v[158:159], v4 offset:17664
    s_waitcnt lgkmcnt(4)
    v_mfma_f32_32x32x16_bf16 v[16:31], v[144:147], v[112:115], v[16:31]
    v_mfma_f32_32x32x16_bf16 v[32:47], v[144:147], v[116:119], v[32:47]
    v_mfma_f32_32x32x16_bf16 v[48:63], v[148:151], v[112:115], v[48:63]
    v_mfma_f32_32x32x16_bf16 v[64:79], v[148:151], v[116:119], v[64:79]
    s_add_u32 s76, s42, 196608
    s_add_u32 s77, s76, 88064
    buffer_load_dwordx4 v[80:83], v3, s[16:19], s76 offen sc1
    buffer_load_dwordx4 v[84:87], v3, s[16:19], s77 offen sc1
    s_add_u32 s76, s42, 208896
    s_add_u32 s77, s76, 88064
    buffer_load_dwordx4 v[88:91], v3, s[16:19], s76 offen sc1
    buffer_load_dwordx4 v[92:95], v3, s[16:19], s77 offen sc1
    s_add_u32 s76, s75, 81920
    s_add_u32 m0, s68, 40960
    s_nop 0
    buffer_load_dwordx4 v250, s[12:15], s76 offen lds
    s_add_u32 s76, s76, 8192
    s_add_u32 m0, s68, 41984
    s_nop 0
    buffer_load_dwordx4 v250, s[12:15], s76 offen lds
    s_waitcnt vmcnt(10)
    ds_read_b64_tr_b16 v[144:145], v4 offset:24576
    ds_read_b64_tr_b16 v[146:147], v4 offset:25600
    ds_read_b64_tr_b16 v[148:149], v4 offset:24832
    ds_read_b64_tr_b16 v[150:151], v4 offset:25856
    s_waitcnt lgkmcnt(4)
    v_mfma_f32_32x32x16_bf16 v[16:31], v[152:155], v[120:123], v[16:31]
    v_mfma_f32_32x32x16_bf16 v[32:47], v[152:155], v[124:127], v[32:47]
    v_mfma_f32_32x32x16_bf16 v[48:63], v[156:159], v[120:123], v[48:63]
    v_mfma_f32_32x32x16_bf16 v[64:79], v[156:159], v[124:127], v[64:79]
    s_add_u32 s76, s42, 221184
    s_add_u32 s77, s76, 88064
    buffer_load_dwordx4 v[96:99], v3, s[16:19], s76 offen sc1
    buffer_load_dwordx4 v[100:103], v3, s[16:19], s77 offen sc1
    s_add_u32 s76, s42, 233472
    s_add_u32 s77, s76, 88064
    buffer_load_dwordx4 v[104:107], v3, s[16:19], s76 offen sc1
    buffer_load_dwordx4 v[108:111], v3, s[16:19], s77 offen sc1
    s_add_u32 s76, s75, 98304
    s_add_u32 m0, s68, 49152
    s_nop 0
    buffer_load_dwordx4 v250, s[12:15], s76 offen lds
    s_add_u32 s76, s76, 8192
    s_add_u32 m0, s68, 50176
    s_nop 0
    buffer_load_dwordx4 v250, s[12:15], s76 offen lds
    s_waitcnt vmcnt(14)
    ds_read_b64_tr_b16 v[152:153], v4 offset:32768
    ds_read_b64_tr_b16 v[154:155], v4 offset:33792
    ds_read_b64_tr_b16 v[156:157], v4 offset:33024
    ds_read_b64_tr_b16 v[158:159], v4 offset:34048
    s_waitcnt lgkmcnt(4)
    v_mfma_f32_32x32x16_bf16 v[16:31], v[144:147], v[128:131], v[16:31]
    v_mfma_f32_32x32x16_bf16 v[32:47], v[144:147], v[132:135], v[32:47]
    v_mfma_f32_32x32x16_bf16 v[48:63], v[148:151], v[128:131], v[48:63]
    v_mfma_f32_32x32x16_bf16 v[64:79], v[148:151], v[132:135], v[64:79]
    s_add_u32 s76, s42, 245760
    s_add_u32 s77, s76, 88064
    buffer_load_dwordx4 v[112:115], v3, s[16:19], s76 offen sc1
    buffer_load_dwordx4 v[116:119], v3, s[16:19], s77 offen sc1
    s_add_u32 s76, s45, 258048
    s_add_u32 s77, s76, 88064
    buffer_load_dwordx4 v[120:123], v3, s[16:19], s76 offen sc1
    buffer_load_dwordx4 v[124:127], v3, s[16:19], s77 offen sc1
    s_add_u32 s76, s75, 114688
    s_add_u32 m0, s68, 57344
    s_nop 0
    buffer_load_dwordx4 v250, s[12:15], s76 offen lds
    s_add_u32 s76, s76, 8192
    s_add_u32 m0, s68, 58368
    s_nop 0
    buffer_load_dwordx4 v250, s[12:15], s76 offen lds
    s_waitcnt vmcnt(16)
    ds_read_b64_tr_b16 v[144:145], v4 offset:40960
    ds_read_b64_tr_b16 v[146:147], v4 offset:41984
    ds_read_b64_tr_b16 v[148:149], v4 offset:41216
    ds_read_b64_tr_b16 v[150:151], v4 offset:42240
    s_waitcnt lgkmcnt(4)
    v_mfma_f32_32x32x16_bf16 v[16:31], v[152:155], v[136:139], v[16:31]
    v_mfma_f32_32x32x16_bf16 v[32:47], v[152:155], v[140:143], v[32:47]
    v_mfma_f32_32x32x16_bf16 v[48:63], v[156:159], v[136:139], v[48:63]
    v_mfma_f32_32x32x16_bf16 v[64:79], v[156:159], v[140:143], v[64:79]
    s_waitcnt vmcnt(14)
    ds_read_b64_tr_b16 v[152:153], v4 offset:49152
    ds_read_b64_tr_b16 v[154:155], v4 offset:50176
    ds_read_b64_tr_b16 v[156:157], v4 offset:49408
    ds_read_b64_tr_b16 v[158:159], v4 offset:50432
    s_waitcnt lgkmcnt(4)
    v_mfma_f32_32x32x16_bf16 v[16:31], v[144:147], v[80:83], v[16:31]
    v_mfma_f32_32x32x16_bf16 v[32:47], v[144:147], v[84:87], v[32:47]
    v_mfma_f32_32x32x16_bf16 v[48:63], v[148:151], v[80:83], v[48:63]
    v_mfma_f32_32x32x16_bf16 v[64:79], v[148:151], v[84:87], v[64:79]
    s_waitcnt vmcnt(10)
    ds_read_b64_tr_b16 v[144:145], v4 offset:57344
    ds_read_b64_tr_b16 v[146:147], v4 offset:58368
    ds_read_b64_tr_b16 v[148:149], v4 offset:57600
    ds_read_b64_tr_b16 v[150:151], v4 offset:58624
    s_waitcnt lgkmcnt(4)
    v_mfma_f32_32x32x16_bf16 v[16:31], v[152:155], v[88:91], v[16:31]
    v_mfma_f32_32x32x16_bf16 v[32:47], v[152:155], v[92:95], v[32:47]
    v_mfma_f32_32x32x16_bf16 v[48:63], v[156:159], v[88:91], v[48:63]
    v_mfma_f32_32x32x16_bf16 v[64:79], v[156:159], v[92:95], v[64:79]
    s_waitcnt vmcnt(8)
    ds_read_b64_tr_b16 v[152:153], v5 offset:0
    ds_read_b64_tr_b16 v[154:155], v5 offset:1024
    ds_read_b64_tr_b16 v[156:157], v5 offset:256
    ds_read_b64_tr_b16 v[158:159], v5 offset:1280
    s_waitcnt lgkmcnt(4)
    v_mfma_f32_32x32x16_bf16 v[16:31], v[144:147], v[96:99], v[16:31]
    v_mfma_f32_32x32x16_bf16 v[32:47], v[144:147], v[100:103], v[32:47]
    v_mfma_f32_32x32x16_bf16 v[48:63], v[148:151], v[96:99], v[48:63]
    v_mfma_f32_32x32x16_bf16 v[64:79], v[148:151], v[100:103], v[64:79]
    s_waitcnt vmcnt(4)
    ds_read_b64_tr_b16 v[144:145], v5 offset:8192
    ds_read_b64_tr_b16 v[146:147], v5 offset:9216
    ds_read_b64_tr_b16 v[148:149], v5 offset:8448
    ds_read_b64_tr_b16 v[150:151], v5 offset:9472
    s_waitcnt lgkmcnt(4)
    v_mfma_f32_32x32x16_bf16 v[16:31], v[152:155], v[104:107], v[16:31]
    v_mfma_f32_32x32x16_bf16 v[32:47], v[152:155], v[108:111], v[32:47]
    v_mfma_f32_32x32x16_bf16 v[48:63], v[156:159], v[104:107], v[48:63]
    v_mfma_f32_32x32x16_bf16 v[64:79], v[156:159], v[108:111], v[64:79]
    s_mov_b32 s79, 0
lw_a:
    ds_read_b32 v249, v251 offset:12
    s_waitcnt lgkmcnt(0)
    v_readfirstlane_b32 s78, v249
    s_nop 0
    s_cmp_lg_u32 s78, 0
    s_cbranch_scc1 ld_a
    s_add_u32 s79, s79, 1
    s_cmp_lt_u32 s79, 524288
    s_cbranch_scc0 ld_a
    s_sleep 1
    s_branch lw_a
ld_a:
    s_add_u32 s76, s72, 0
    s_add_u32 s77, s76, 32768
    buffer_load_dwordx4 v[128:131], v3, s[20:23], s76 offen sc1
    buffer_load_dwordx4 v[132:135], v3, s[20:23], s77 offen sc1
    s_add_u32 s76, s72, 1024
    s_add_u32 s77, s76, 32768
    buffer_load_dwordx4 v[136:139], v3, s[20:23], s76 offen sc1
    buffer_load_dwordx4 v[140:143], v3, s[20:23], s77 offen sc1
    s_waitcnt vmcnt(6)
    ds_read_b64_tr_b16 v[152:153], v5 offset:16384
    ds_read_b64_tr_b16 v[154:155], v5 offset:17408
    ds_read_b64_tr_b16 v[156:157], v5 offset:16640
    ds_read_b64_tr_b16 v[158:159], v5 offset:17664
    s_waitcnt lgkmcnt(4)
    v_mfma_f32_32x32x16_bf16 v[16:31], v[144:147], v[112:115], v[16:31]
    v_mfma_f32_32x32x16_bf16 v[32:47], v[144:147], v[116:119], v[32:47]
    v_mfma_f32_32x32x16_bf16 v[48:63], v[148:151], v[112:115], v[48:63]
    v_mfma_f32_32x32x16_bf16 v[64:79], v[148:151], v[116:119], v[64:79]
    s_add_u32 s76, s72, 2048
    s_add_u32 s77, s76, 32768
    buffer_load_dwordx4 v[80:83], v3, s[20:23], s76 offen sc1
    buffer_load_dwordx4 v[84:87], v3, s[20:23], s77 offen sc1
    s_add_u32 s76, s72, 3072
    s_add_u32 s77, s76, 32768
    buffer_load_dwordx4 v[88:91], v3, s[20:23], s76 offen sc1
    buffer_load_dwordx4 v[92:95], v3, s[20:23], s77 offen sc1
    s_waitcnt vmcnt(6)
    ds_read_b64_tr_b16 v[144:145], v5 offset:24576
    ds_read_b64_tr_b16 v[146:147], v5 offset:25600
    ds_read_b64_tr_b16 v[148:149], v5 offset:24832
    ds_read_b64_tr_b16 v[150:151], v5 offset:25856
    s_waitcnt lgkmcnt(4)
    v_mfma_f32_32x32x16_bf16 v[16:31], v[152:155], v[120:123], v[16:31]
    v_mfma_f32_32x32x16_bf16 v[32:47], v[152:155], v[124:127], v[32:47]
    v_mfma_f32_32x32x16_bf16 v[48:63], v[156:159], v[120:123], v[48:63]
    v_mfma_f32_32x32x16_bf16 v[64:79], v[156:159], v[124:127], v[64:79]
    s_add_u32 s76, s72, 4096
    s_add_u32 s77, s76, 32768
    buffer_load_dwordx4 v[96:99], v3, s[20:23], s76 offen sc1
    buffer_load_dwordx4 v[100:103], v3, s[20:23], s77 offen sc1
    s_add_u32 s76, s72, 5120
    s_add_u32 s77, s76, 32768
    buffer_load_dwordx4 v[104:107], v3, s[20:23], s76 offen sc1
    buffer_load_dwordx4 v[108:111], v3, s[20:23], s77 offen sc1
    s_waitcnt vmcnt(8)
    ds_read_b64_tr_b16 v[152:153], v5 offset:32768
    ds_read_b64_tr_b16 v[154:155], v5 offset:33792
    ds_read_b64_tr_b16 v[156:157], v5 offset:33024
    ds_read_b64_tr_b16 v[158:159], v5 offset:34048
    s_waitcnt lgkmcnt(4)
    v_mfma_f32_32x32x16_bf16 v[160:175], v[144:147], v[128:131], 0
    v_mfma_f32_32x32x16_bf16 v[176:191], v[144:147], v[132:135], 0
    v_mfma_f32_32x32x16_bf16 v[192:207], v[148:151], v[128:131], 0
    v_mfma_f32_32x32x16_bf16 v[208:223], v[148:151], v[132:135], 0
    s_add_u32 s76, s72, 6144
    s_add_u32 s77, s76, 32768
    buffer_load_dwordx4 v[112:115], v3, s[20:23], s76 offen sc1
    buffer_load_dwordx4 v[116:119], v3, s[20:23], s77 offen sc1
    s_add_u32 s76, s72, 7168
    s_add_u32 s77, s76, 32768
    buffer_load_dwordx4 v[120:123], v3, s[20:23], s76 offen sc1
    buffer_load_dwordx4 v[124:127], v3, s[20:23], s77 offen sc1
    s_waitcnt vmcnt(10)
    ds_read_b64_tr_b16 v[144:145], v5 offset:40960
    ds_read_b64_tr_b16 v[146:147], v5 offset:41984
    ds_read_b64_tr_b16 v[148:149], v5 offset:41216
    ds_read_b64_tr_b16 v[150:151], v5 offset:42240
    s_waitcnt lgkmcnt(4)
    v_mfma_f32_32x32x16_bf16 v[160:175], v[152:155], v[136:139], v[160:175]
    v_mfma_f32_32x32x16_bf16 v[176:191], v[152:155], v[140:143], v[176:191]
    v_mfma_f32_32x32x16_bf16 v[192:207], v[156:159], v[136:139], v[192:207]
    v_mfma_f32_32x32x16_bf16 v[208:223], v[156:159], v[140:143], v[208:223]
    s_waitcnt vmcnt(8)
    ds_read_b64_tr_b16 v[152:153], v5 offset:49152
    ds_read_b64_tr_b16 v[154:155], v5 offset:50176
    ds_read_b64_tr_b16 v[156:157], v5 offset:49408
    ds_read_b64_tr_b16 v[158:159], v5 offset:50432
    s_waitcnt lgkmcnt(4)
    v_mfma_f32_32x32x16_bf16 v[160:175], v[144:147], v[80:83], v[160:175]
    v_mfma_f32_32x32x16_bf16 v[176:191], v[144:147], v[84:87], v[176:191]
    v_mfma_f32_32x32x16_bf16 v[192:207], v[148:151], v[80:83], v[192:207]
    v_mfma_f32_32x32x16_bf16 v[208:223], v[148:151], v[84:87], v[208:223]
    s_waitcnt vmcnt(6)
    ds_read_b64_tr_b16 v[144:145], v4 offset:0
    ds_read_b64_tr_b16 v[146:147], v4 offset:1024
    ds_read_b64_tr_b16 v[148:149], v4 offset:256
    ds_read_b64_tr_b16 v[150:151], v4 offset:1280
    s_waitcnt lgkmcnt(4)
    v_mfma_f32_32x32x16_bf16 v[160:175], v[152:155], v[88:91], v[160:175]
    v_mfma_f32_32x32x16_bf16 v[176:191], v[152:155], v[92:95], v[176:191]
    v_mfma_f32_32x32x16_bf16 v[192:207], v[156:159], v[88:91], v[192:207]
    v_mfma_f32_32x32x16_bf16 v[208:223], v[156:159], v[92:95], v[208:223]
    s_waitcnt vmcnt(4)
    ds_read_b64_tr_b16 v[152:153], v4 offset:8192
    ds_read_b64_tr_b16 v[154:155], v4 offset:9216
    ds_read_b64_tr_b16 v[156:157], v4 offset:8448
    ds_read_b64_tr_b16 v[158:159], v4 offset:9472
    s_waitcnt lgkmcnt(4)
    v_mfma_f32_32x32x16_bf16 v[160:175], v[144:147], v[96:99], v[160:175]
    v_mfma_f32_32x32x16_bf16 v[176:191], v[144:147], v[100:103], v[176:191]
    v_mfma_f32_32x32x16_bf16 v[192:207], v[148:151], v[96:99], v[192:207]
    v_mfma_f32_32x32x16_bf16 v[208:223], v[148:151], v[100:103], v[208:223]
    s_waitcnt vmcnt(2)
    ds_read_b64_tr_b16 v[144:145], v4 offset:16384
    ds_read_b64_tr_b16 v[146:147], v4 offset:17408
    ds_read_b64_tr_b16 v[148:149], v4 offset:16640
    ds_read_b64_tr_b16 v[150:151], v4 offset:17664
    s_waitcnt lgkmcnt(4)
    v_mfma_f32_32x32x16_bf16 v[160:175], v[152:155], v[104:107], v[160:175]
    v_mfma_f32_32x32x16_bf16 v[176:191], v[152:155], v[108:111], v[176:191]
    v_mfma_f32_32x32x16_bf16 v[192:207], v[156:159], v[104:107], v[192:207]
    v_mfma_f32_32x32x16_bf16 v[208:223], v[156:159], v[108:111], v[208:223]
    s_waitcnt vmcnt(0)
    ds_read_b64_tr_b16 v[152:153], v4 offset:24576
    ds_read_b64_tr_b16 v[154:155], v4 offset:25600
    ds_read_b64_tr_b16 v[156:157], v4 offset:24832
    ds_read_b64_tr_b16 v[158:159], v4 offset:25856
    s_waitcnt lgkmcnt(4)
    v_mfma_f32_32x32x16_bf16 v[160:175], v[144:147], v[112:115], v[160:175]
    v_mfma_f32_32x32x16_bf16 v[176:191], v[144:147], v[116:119], v[176:191]
    v_mfma_f32_32x32x16_bf16 v[192:207], v[148:151], v[112:115], v[192:207]
    v_mfma_f32_32x32x16_bf16 v[208:223], v[148:151], v[116:119], v[208:223]
    s_waitcnt lgkmcnt(0)
    v_mfma_f32_32x32x16_bf16 v[160:175], v[152:155], v[120:123], v[160:175]
    v_mfma_f32_32x32x16_bf16 v[176:191], v[152:155], v[124:127], v[176:191]
    v_mfma_f32_32x32x16_bf16 v[192:207], v[156:159], v[120:123], v[192:207]
    v_mfma_f32_32x32x16_bf16 v[208:223], v[156:159], v[124:127], v[208:223]
    v_sub_f32 v12, 1.0, v10
    v_sub_f32 v13, 1.0, v11
    v_mul_f32 v16, v16, v12
    v_mul_f32 v17, v17, v12
    v_mul_f32 v18, v18, v12
    v_mul_f32 v19, v19, v12
    v_mul_f32 v20, v20, v12
    v_mul_f32 v21, v21, v12
    v_mul_f32 v22, v22, v12
    v_mul_f32 v23, v23, v12
    v_mul_f32 v24, v24, v12
    v_mul_f32 v25, v25, v12
    v_mul_f32 v26, v26, v12
    v_mul_f32 v27, v27, v12
    v_mul_f32 v28, v28, v12
    v_mul_f32 v29, v29, v12
    v_mul_f32 v30, v30, v12
    v_mul_f32 v31, v31, v12
    v_fma_f32 v16, v160, v10, v16
    v_fma_f32 v17, v161, v10, v17
    v_fma_f32 v18, v162, v10, v18
    v_fma_f32 v19, v163, v10, v19
    v_fma_f32 v20, v164, v10, v20
    v_fma_f32 v21, v165, v10, v21
    v_fma_f32 v22, v166, v10, v22
    v_fma_f32 v23, v167, v10, v23
    v_fma_f32 v24, v168, v10, v24
    v_fma_f32 v25, v169, v10, v25
    v_fma_f32 v26, v170, v10, v26
    v_fma_f32 v27, v171, v10, v27
    v_fma_f32 v28, v172, v10, v28
    v_fma_f32 v29, v173, v10, v29
    v_fma_f32 v30, v174, v10, v30
    v_fma_f32 v31, v175, v10, v31
    v_mul_f32 v32, v32, v13
    v_mul_f32 v33, v33, v13
    v_mul_f32 v34, v34, v13
    v_mul_f32 v35, v35, v13
    v_mul_f32 v36, v36, v13
    v_mul_f32 v37, v37, v13
    v_mul_f32 v38, v38, v13
    v_mul_f32 v39, v39, v13
    v_mul_f32 v40, v40, v13
    v_mul_f32 v41, v41, v13
    v_mul_f32 v42, v42, v13
    v_mul_f32 v43, v43, v13
    v_mul_f32 v44, v44, v13
    v_mul_f32 v45, v45, v13
    v_mul_f32 v46, v46, v13
    v_mul_f32 v47, v47, v13
    v_fma_f32 v32, v176, v11, v32
    v_fma_f32 v33, v177, v11, v33
    v_fma_f32 v34, v178, v11, v34
    v_fma_f32 v35, v179, v11, v35
    v_fma_f32 v36, v180, v11, v36
    v_fma_f32 v37, v181, v11, v37
    v_fma_f32 v38, v182, v11, v38
    v_fma_f32 v39, v183, v11, v39
    v_fma_f32 v40, v184, v11, v40
    v_fma_f32 v41, v185, v11, v41
    v_fma_f32 v42, v186, v11, v42
    v_fma_f32 v43, v187, v11, v43
    v_fma_f32 v44, v188, v11, v44
    v_fma_f32 v45, v189, v11, v45
    v_fma_f32 v46, v190, v11, v46
    v_fma_f32 v47, v191, v11, v47
    v_mul_f32 v48, v48, v12
    v_mul_f32 v49, v49, v12
    v_mul_f32 v50, v50, v12
    v_mul_f32 v51, v51, v12
    v_mul_f32 v52, v52, v12
    v_mul_f32 v53, v53, v12
    v_mul_f32 v54, v54, v12
    v_mul_f32 v55, v55, v12
    v_mul_f32 v56, v56, v12
    v_mul_f32 v57, v57, v12
    v_mul_f32 v58, v58, v12
    v_mul_f32 v59, v59, v12
    v_mul_f32 v60, v60, v12
    v_mul_f32 v61, v61, v12
    v_mul_f32 v62, v62, v12
    v_mul_f32 v63, v63, v12
    v_fma_f32 v48, v192, v10, v48
    v_fma_f32 v49, v193, v10, v49
    v_fma_f32 v50, v194, v10, v50
    v_fma_f32 v51, v195, v10, v51
    v_fma_f32 v52, v196, v10, v52
    v_fma_f32 v53, v197, v10, v53
    v_fma_f32 v54, v198, v10, v54
    v_fma_f32 v55, v199, v10, v55
    v_fma_f32 v56, v200, v10, v56
    v_fma_f32 v57, v201, v10, v57
    v_fma_f32 v58, v202, v10, v58
    v_fma_f32 v59, v203, v10, v59
    v_fma_f32 v60, v204, v10, v60
    v_fma_f32 v61, v205, v10, v61
    v_fma_f32 v62, v206, v10, v62
    v_fma_f32 v63, v207, v10, v63
    v_mul_f32 v64, v64, v13
    v_mul_f32 v65, v65, v13
    v_mul_f32 v66, v66, v13
    v_mul_f32 v67, v67, v13
    v_mul_f32 v68, v68, v13
    v_mul_f32 v69, v69, v13
    v_mul_f32 v70, v70, v13
    v_mul_f32 v71, v71, v13
    v_mul_f32 v72, v72, v13
    v_mul_f32 v73, v73, v13
    v_mul_f32 v74, v74, v13
    v_mul_f32 v75, v75, v13
    v_mul_f32 v76, v76, v13
    v_mul_f32 v77, v77, v13
    v_mul_f32 v78, v78, v13
    v_mul_f32 v79, v79, v13
    v_fma_f32 v64, v208, v11, v64
    v_fma_f32 v65, v209, v11, v65
    v_fma_f32 v66, v210, v11, v66
    v_fma_f32 v67, v211, v11, v67
    v_fma_f32 v68, v212, v11, v68
    v_fma_f32 v69, v213, v11, v69
    v_fma_f32 v70, v214, v11, v70
    v_fma_f32 v71, v215, v11, v71
    v_fma_f32 v72, v216, v11, v72
    v_fma_f32 v73, v217, v11, v73
    v_fma_f32 v74, v218, v11, v74
    v_fma_f32 v75, v219, v11, v75
    v_fma_f32 v76, v220, v11, v76
    v_fma_f32 v77, v221, v11, v77
    v_fma_f32 v78, v222, v11, v78
    v_fma_f32 v79, v223, v11, v79
    s_barrier
    s_cmp_eq_u32 s6, 0
    s_cbranch_scc1 k2_sk0
    s_sub_u32 s3, s6, 1
    s_and_b32 s3, s3, 3
    s_lshl_b32 s3, s3, 12
    s_add_u32 s3, s3, 0
    v_add_u32 v5, s3, v3
    ds_write_b128 v5, v[16:19] offset:0
    ds_write_b128 v5, v[20:23] offset:1024
    ds_write_b128 v5, v[24:27] offset:2048
    ds_write_b128 v5, v[28:31] offset:3072
k2_sk0:
    s_cmp_eq_u32 s6, 1
    s_cbranch_scc1 k2_sk1
    s_sub_u32 s3, s6, 2
    s_and_b32 s3, s3, 3
    s_lshl_b32 s3, s3, 12
    s_add_u32 s3, s3, 12288
    v_add_u32 v5, s3, v3
    ds_write_b128 v5, v[32:35] offset:0
    ds_write_b128 v5, v[36:39] offset:1024
    ds_write_b128 v5, v[40:43] offset:2048
    ds_write_b128 v5, v[44:47] offset:3072
k2_sk1:
    s_cmp_eq_u32 s6, 2
    s_cbranch_scc1 k2_sk2
    s_sub_u32 s3, s6, 3
    s_and_b32 s3, s3, 3
    s_lshl_b32 s3, s3, 12
    s_add_u32 s3, s3, 24576
    v_add_u32 v5, s3, v3
    ds_write_b128 v5, v[48:51] offset:0
    ds_write_b128 v5, v[52:55] offset:1024
    ds_write_b128 v5, v[56:59] offset:2048
    ds_write_b128 v5, v[60:63] offset:3072
k2_sk2:
    s_cmp_eq_u32 s6, 3
    s_cbranch_scc1 k2_sk3
    s_sub_u32 s3, s6, 4
    s_and_b32 s3, s3, 3
    s_lshl_b32 s3, s3, 12
    s_add_u32 s3, s3, 36864
    v_add_u32 v5, s3, v3
    ds_write_b128 v5, v[64:67] offset:0
    ds_write_b128 v5, v[68:71] offset:1024
    ds_write_b128 v5, v[72:75] offset:2048
    ds_write_b128 v5, v[76:79] offset:3072
k2_sk3:
    s_waitcnt lgkmcnt(0)
    s_barrier
    s_mul_i32 s3, s6, 12288
    v_add_u32 v5, s3, v3
    ds_read_b128 v[80:83], v5 offset:0
    ds_read_b128 v[84:87], v5 offset:1024
    ds_read_b128 v[88:91], v5 offset:2048
    ds_read_b128 v[92:95], v5 offset:3072
    ds_read_b128 v[96:99], v5 offset:4096
    ds_read_b128 v[100:103], v5 offset:5120
    ds_read_b128 v[104:107], v5 offset:6144
    ds_read_b128 v[108:111], v5 offset:7168
    ds_read_b128 v[112:115], v5 offset:8192
    ds_read_b128 v[116:119], v5 offset:9216
    ds_read_b128 v[120:123], v5 offset:10240
    ds_read_b128 v[124:127], v5 offset:11264
    s_cmp_lg_u32 s6, 0
    s_cbranch_scc1 k2_mv0
    v_mov_b32 v144, v16
    v_mov_b32 v145, v17
    v_mov_b32 v146, v18
    v_mov_b32 v147, v19
    v_mov_b32 v148, v20
    v_mov_b32 v149, v21
    v_mov_b32 v150, v22
    v_mov_b32 v151, v23
    v_mov_b32 v152, v24
    v_mov_b32 v153, v25
    v_mov_b32 v154, v26
    v_mov_b32 v155, v27
    v_mov_b32 v156, v28
    v_mov_b32 v157, v29
    v_mov_b32 v158, v30
    v_mov_b32 v159, v31
    v_mov_b32 v14, v12
k2_mv0:
    s_cmp_lg_u32 s6, 1
    s_cbranch_scc1 k2_mv1
    v_mov_b32 v144, v32
    v_mov_b32 v145, v33
    v_mov_b32 v146, v34
    v_mov_b32 v147, v35
    v_mov_b32 v148, v36
    v_mov_b32 v149, v37
    v_mov_b32 v150, v38
    v_mov_b32 v151, v39
    v_mov_b32 v152, v40
    v_mov_b32 v153, v41
    v_mov_b32 v154, v42
    v_mov_b32 v155, v43
    v_mov_b32 v156, v44
    v_mov_b32 v157, v45
    v_mov_b32 v158, v46
    v_mov_b32 v159, v47
    v_mov_b32 v14, v13
k2_mv1:
    s_cmp_lg_u32 s6, 2
    s_cbranch_scc1 k2_mv2
    v_mov_b32 v144, v48
    v_mov_b32 v145, v49
    v_mov_b32 v146, v50
    v_mov_b32 v147, v51
    v_mov_b32 v148, v52
    v_mov_b32 v149, v53
    v_mov_b32 v150, v54
    v_mov_b32 v151, v55
    v_mov_b32 v152, v56
    v_mov_b32 v153, v57
    v_mov_b32 v154, v58
    v_mov_b32 v155, v59
    v_mov_b32 v156, v60
    v_mov_b32 v157, v61
    v_mov_b32 v158, v62
    v_mov_b32 v159, v63
    v_mov_b32 v14, v12
k2_mv2:
    s_cmp_lg_u32 s6, 3
    s_cbranch_scc1 k2_mv3
    v_mov_b32 v144, v64
    v_mov_b32 v145, v65
    v_mov_b32 v146, v66
    v_mov_b32 v147, v67
    v_mov_b32 v148, v68
    v_mov_b32 v149, v69
    v_mov_b32 v150, v70
    v_mov_b32 v151, v71
    v_mov_b32 v152, v72
    v_mov_b32 v153, v73
    v_mov_b32 v154, v74
    v_mov_b32 v155, v75
    v_mov_b32 v156, v76
    v_mov_b32 v157, v77
    v_mov_b32 v158, v78
    v_mov_b32 v159, v79
    v_mov_b32 v14, v13
k2_mv3:
    s_waitcnt lgkmcnt(0)
    v_add_f32 v144, v144, v80
    v_add_f32 v145, v145, v81
    v_add_f32 v146, v146, v82
    v_add_f32 v147, v147, v83
    v_add_f32 v148, v148, v84
    v_add_f32 v149, v149, v85
    v_add_f32 v150, v150, v86
    v_add_f32 v151, v151, v87
    v_add_f32 v152, v152, v88
    v_add_f32 v153, v153, v89
    v_add_f32 v154, v154, v90
    v_add_f32 v155, v155, v91
    v_add_f32 v156, v156, v92
    v_add_f32 v157, v157, v93
    v_add_f32 v158, v158, v94
    v_add_f32 v159, v159, v95
    v_add_f32 v144, v144, v96
    v_add_f32 v145, v145, v97
    v_add_f32 v146, v146, v98
    v_add_f32 v147, v147, v99
    v_add_f32 v148, v148, v100
    v_add_f32 v149, v149, v101
    v_add_f32 v150, v150, v102
    v_add_f32 v151, v151, v103
    v_add_f32 v152, v152, v104
    v_add_f32 v153, v153, v105
    v_add_f32 v154, v154, v106
    v_add_f32 v155, v155, v107
    v_add_f32 v156, v156, v108
    v_add_f32 v157, v157, v109
    v_add_f32 v158, v158, v110
    v_add_f32 v159, v159, v111
    v_add_f32 v144, v144, v112
    v_add_f32 v145, v145, v113
    v_add_f32 v146, v146, v114
    v_add_f32 v147, v147, v115
    v_add_f32 v148, v148, v116
    v_add_f32 v149, v149, v117
    v_add_f32 v150, v150, v118
    v_add_f32 v151, v151, v119
    v_add_f32 v152, v152, v120
    v_add_f32 v153, v153, v121
    v_add_f32 v154, v154, v122
    v_add_f32 v155, v155, v123
    v_add_f32 v156, v156, v124
    v_add_f32 v157, v157, v125
    v_add_f32 v158, v158, v126
    v_add_f32 v159, v159, v127
    v_lshlrev_b32 v80, 16, v240
    v_and_b32 v81, 0xffff0000, v240
    v_lshlrev_b32 v82, 16, v241
    v_and_b32 v83, 0xffff0000, v241
    v_fma_f32 v144, v80, v14, v144
    v_fma_f32 v145, v81, v14, v145
    v_fma_f32 v146, v82, v14, v146
    v_fma_f32 v147, v83, v14, v147
    v_lshlrev_b32 v80, 16, v242
    v_and_b32 v81, 0xffff0000, v242
    v_lshlrev_b32 v82, 16, v243
    v_and_b32 v83, 0xffff0000, v243
    v_fma_f32 v148, v80, v14, v148
    v_fma_f32 v149, v81, v14, v149
    v_fma_f32 v150, v82, v14, v150
    v_fma_f32 v151, v83, v14, v151
    v_lshlrev_b32 v80, 16, v244
    v_and_b32 v81, 0xffff0000, v244
    v_lshlrev_b32 v82, 16, v245
    v_and_b32 v83, 0xffff0000, v245
    v_fma_f32 v152, v80, v14, v152
    v_fma_f32 v153, v81, v14, v153
    v_fma_f32 v154, v82, v14, v154
    v_fma_f32 v155, v83, v14, v155
    v_lshlrev_b32 v80, 16, v246
    v_and_b32 v81, 0xffff0000, v246
    v_lshlrev_b32 v82, 16, v247
    v_and_b32 v83, 0xffff0000, v247
    v_fma_f32 v156, v80, v14, v156
    v_fma_f32 v157, v81, v14, v157
    v_fma_f32 v158, v82, v14, v158
    v_fma_f32 v159, v83, v14, v159
    v_cvt_pk_bf16_f32 v160, v144, v145
    v_cvt_pk_bf16_f32 v161, v146, v147
    v_cvt_pk_bf16_f32 v162, v148, v149
    v_cvt_pk_bf16_f32 v163, v150, v151
    v_cvt_pk_bf16_f32 v164, v152, v153
    v_cvt_pk_bf16_f32 v165, v154, v155
    v_cvt_pk_bf16_f32 v166, v156, v157
    v_cvt_pk_bf16_f32 v167, v158, v159
    v_permlane32_swap_b32 v160, v162
    v_permlane32_swap_b32 v161, v163
    v_permlane32_swap_b32 v164, v166
    v_permlane32_swap_b32 v165, v167
    s_lshl_b32 s3, s4, 6
    s_and_b32 s59, s6, 1
    s_lshl_b32 s59, s59, 5
    s_add_u32 s3, s3, s59
    v_add_u32 v5, s3, v7
    v_lshlrev_b32 v5, 10, v5
    v_lshl_add_u32 v5, v15, 4, v5
    s_lshl_b32 s3, s5, 7
    s_lshr_b32 s59, s6, 1
    s_lshl_b32 s59, s59, 6
    s_add_u32 s3, s3, s59
    buffer_store_dwordx4 v[160:163], v5, s[64:67], s3 offen
    buffer_store_dwordx4 v[164:167], v5, s[64:67], s3 offen offset:32
    s_endpgm
helper:
    s_nop 7
    s_nop 7
    s_mov_b64 exec, 0x1f
    s_mov_b32 s79, 0
    s_sleep 1
    v_mov_b32 v247, 0
    buffer_atomic_add v247, v244, s[16:19], 0 offen sc0
hm_loop:
    s_waitcnt vmcnt(1)
    v_cmp_eq_u32 vcc, v246, v245
    s_nop 0
    s_mov_b64 s[62:63], vcc
    s_bitcmp1_b32 s60, 0
    s_cbranch_scc1 hm_noh0a
    s_bitcmp1_b32 s62, 0
    s_cbranch_scc0 hm_noh0a
    ds_write_b32 v9, v10 offset:0
    s_or_b32 s60, s60, 1
hm_noh0a:
    s_bitcmp1_b32 s60, 1
    s_cbranch_scc1 hm_noh1a
    s_bitcmp1_b32 s62, 1
    s_cbranch_scc0 hm_noh1a
    ds_write_b32 v9, v10 offset:4
    s_or_b32 s60, s60, 2
hm_noh1a:
    s_bitcmp1_b32 s60, 2
    s_cbranch_scc1 hm_noh2a
    s_bitcmp1_b32 s62, 2
    s_cbranch_scc0 hm_noh2a
    ds_write_b32 v9, v10 offset:8
    s_or_b32 s60, s60, 4
hm_noh2a:
    s_bitcmp1_b32 s60, 3
    s_cbranch_scc1 hm_noh3a
    s_bitcmp1_b32 s62, 3
    s_cbranch_scc0 hm_noh3a
    ds_write_b32 v9, v10 offset:12
    s_or_b32 s60, s60, 8
hm_noh3a:
    s_bitcmp1_b32 s60, 4
    s_cbranch_scc1 hm_noh4a
    s_bitcmp1_b32 s62, 4
    s_cbranch_scc0 hm_noh4a
    ds_write_b32 v9, v10 offset:28
    s_or_b32 s60, s60, 16
hm_noh4a:
    s_cmp_eq_u32 s60, 31
    s_cbranch_scc1 hm_done
    v_mov_b32 v246, 0
    buffer_atomic_add v246, v244, s[16:19], 0 offen sc0
    s_sleep 1
    s_waitcnt vmcnt(1)
    v_cmp_eq_u32 vcc, v247, v245
    s_nop 0
    s_mov_b64 s[62:63], vcc
    s_bitcmp1_b32 s60, 0
    s_cbranch_scc1 hm_noh0b
    s_bitcmp1_b32 s62, 0
    s_cbranch_scc0 hm_noh0b
    ds_write_b32 v9, v10 offset:0
    s_or_b32 s60, s60, 1
hm_noh0b:
    s_bitcmp1_b32 s60, 1
    s_cbranch_scc1 hm_noh1b
    s_bitcmp1_b32 s62, 1
    s_cbranch_scc0 hm_noh1b
    ds_write_b32 v9, v10 offset:4
    s_or_b32 s60, s60, 2
hm_noh1b:
    s_bitcmp1_b32 s60, 2
    s_cbranch_scc1 hm_noh2b
    s_bitcmp1_b32 s62, 2
    s_cbranch_scc0 hm_noh2b
    ds_write_b32 v9, v10 offset:8
    s_or_b32 s60, s60, 4
hm_noh2b:
    s_bitcmp1_b32 s60, 3
    s_cbranch_scc1 hm_noh3b
    s_bitcmp1_b32 s62, 3
    s_cbranch_scc0 hm_noh3b
    ds_write_b32 v9, v10 offset:12
    s_or_b32 s60, s60, 8
hm_noh3b:
    s_bitcmp1_b32 s60, 4
    s_cbranch_scc1 hm_noh4b
    s_bitcmp1_b32 s62, 4
    s_cbranch_scc0 hm_noh4b
    ds_write_b32 v9, v10 offset:28
    s_or_b32 s60, s60, 16
hm_noh4b:
    s_cmp_eq_u32 s60, 31
    s_cbranch_scc1 hm_done
    v_mov_b32 v247, 0
    buffer_atomic_add v247, v244, s[16:19], 0 offen sc0
    s_add_u32 s79, s79, 1
    s_cmp_lt_u32 s79, 65536
    s_cbranch_scc0 hm_fail
    s_sleep 1
    s_branch hm_loop
hm_fail:
    ds_write_b32 v9, v10 offset:0
    ds_write_b32 v9, v10 offset:4
    ds_write_b32 v9, v10 offset:8
    ds_write_b32 v9, v10 offset:12
    ds_write_b32 v9, v10 offset:28
hm_done:
    s_waitcnt vmcnt(0) lgkmcnt(0)
    s_endpgm
k1_exit:
    s_endpgm
.section .rodata,"a"
.p2align 6
.amdhsa_kernel fused_kernel
  .amdhsa_next_free_vgpr 256
  .amdhsa_next_free_sgpr 102
  .amdhsa_accum_offset 256
  .amdhsa_group_segment_fixed_size 0
  .amdhsa_kernarg_size 104
  .amdhsa_user_sgpr_count 2
  .amdhsa_user_sgpr_kernarg_segment_ptr 1
  .amdhsa_system_sgpr_workgroup_id_x 1
.end_amdhsa_kernel
```
